```python
import torch

def _softmax(x, axis=-1):
    return torch.softmax(x, dim=axis)
def _gelu(x):
    return torch.nn.functional.gelu(x, approximate="tanh")
def _silu(x):
    return torch.nn.functional.silu(x)
def _sigmoid(x):
    return torch.sigmoid(x)
def _layernorm(x, axis=-1, eps=1e-5):
    m = x.mean(dim=axis, keepdim=True)
    v = x.var(dim=axis, keepdim=True, unbiased=False)
    return (x - m) / torch.sqrt(v + eps)
def _scatter_add(tgt, idx, src, axis=0):
    return tgt.clone().index_add_(axis, idx, src)
def _segment_sum(src, seg, n):
    out = torch.zeros((n,) + src.shape[1:], dtype=src.dtype)
    return out.index_add_(0, seg, src)
def _pad(x, pw):
    flat = tuple(v for pair in reversed(pw) for v in pair)
    return torch.nn.functional.pad(x, flat)

kernel_name = 'parallel_sum__sliding_block_cached__swiglu_ffn__decode'

def setup_inputs():

    _w = (lambda a: (lambda t: t.to(torch.bfloat16) if t.is_floating_point() else t)(torch.as_tensor(a)))
    def _A_setup():
        B, Sq, D = 2, 1, 512
        Hq, Hkv, Sk, Dh = 32, 8, 32768, 128
        assert Hq % Hkv == 0, (Hq, Hkv)
        return {
            "x": _w((lambda *s: torch.randn(*s, dtype=torch.bfloat16) * 0.05)(B, Sq, D)),
            "k_cache": _w((lambda *s: torch.randn(*s, dtype=torch.bfloat16) * 3.2)(B, Hkv, Sk, Dh)),
            "v_cache": _w((lambda *s: torch.randn(*s, dtype=torch.bfloat16) * 1.6)(B, Hkv, Sk, Dh)),
            "wq": _w((lambda *s: torch.randn(*s, dtype=torch.bfloat16) * 3.2)(D, Hq * Dh) * (D ** -0.5)),
            "wo": _w((lambda *s: torch.randn(*s, dtype=torch.bfloat16) * 1.6)(Hq * Dh, D) * ((Hq * Dh) ** -0.5)),
        }
    _A_in = _A_setup()

    def _B_setup():
        B, S, D, F = 2, 1, 512, 1792
        return {
            "x": _w((lambda *s: torch.randn(*s, dtype=torch.bfloat16) * 0.05)(B, S, D)),
            "w_gate": _w((lambda *s: torch.randn(*s, dtype=torch.bfloat16) * 0.05)(D, F)),
            "w_up": _w((lambda *s: torch.randn(*s, dtype=torch.bfloat16) * 0.05)(D, F)),
            "w_down": _w((lambda *s: torch.randn(*s, dtype=torch.bfloat16) * 0.05)(F, D)),
        }
    _B_in = _B_setup()

    return {
        "A_x": _A_in["x"],
        "A_k_cache": _A_in["k_cache"],
        "A_v_cache": _A_in["v_cache"],
        "A_wq": _A_in["wq"],
        "A_wo": _A_in["wo"],
        "B_x": _B_in["x"],
        "B_w_gate": _B_in["w_gate"],
        "B_w_up": _B_in["w_up"],
        "B_w_down": _B_in["w_down"],
    }

def reference(A_x, A_k_cache, A_v_cache, A_wq, A_wo, B_x, B_w_gate, B_w_up, B_w_down):
    def _A_ref(x, k_cache, v_cache, wq, wo):
        B, Sq, D = x.shape
        Hq, Dh = 32, 128
        Hkv, Sk = k_cache.shape[1], k_cache.shape[2]
        W = min(4096, max(256, Sk // 4))
        rep = Hq // Hkv
        q = (lambda x, *d: x.permute(*d))((x @ wq).reshape(B, Sq, Hq, Dh), 0, 2, 1, 3)
        k = (lambda x, n, axis: torch.repeat_interleave(x, n, dim=axis))(k_cache[:, :, Sk - W:, :], rep, axis=1)
        v = (lambda x, n, axis: torch.repeat_interleave(x, n, dim=axis))(v_cache[:, :, Sk - W:, :], rep, axis=1)
        scores = torch.einsum("bhqd,bhkd->bhqk", q, k) * (Dh ** -0.5)
        p = _softmax(scores, axis=-1)
        o = torch.einsum("bhqk,bhkd->bhqd", p, v)
        return (lambda x, *d: x.permute(*d))(o, 0, 2, 1, 3).reshape(B, Sq, Hq * Dh) @ wo

    def _B_ref(x, w_gate, w_up, w_down):
        g = _silu(x @ w_gate)
        u = x @ w_up
        return (g * u) @ w_down

    x = A_x
    xn = _layernorm(x, axis=-1)
    return x + _A_ref(xn, A_k_cache, A_v_cache, A_wq, A_wo) + _B_ref(xn, B_w_gate, B_w_up, B_w_down)
```

```asm
; @launch grid=(256,1,1) block=(832,1,1) lds=153600
.amdgcn_target "amdgcn-amd-amdhsa--gfx950"
.text
.globl parallel_sum__sliding_block_cached__swiglu_ffn__decode_kernel
.p2align 8
.type parallel_sum__sliding_block_cached__swiglu_ffn__decode_kernel,@function
parallel_sum__sliding_block_cached__swiglu_ffn__decode_kernel:
    s_cmp_ge_u32 s2, 256
    s_cbranch_scc1 L_end
    s_load_dwordx16 s[16:31], s[0:1], 0
    s_load_dwordx8 s[32:39], s[0:1], 64
    v_lshrrev_b32 v1, 6, v0
    v_and_b32 v2, 63, v0
    s_nop 0
    v_readfirstlane_b32 s3, v1
    s_lshr_b32 s4, s2, 4
    s_and_b32 s5, s2, 15
    s_waitcnt lgkmcnt(0)
    s_cmp_eq_u32 s3, 12
    s_cbranch_scc1 L_nonce
    s_cmp_ge_u32 s3, 8
    s_cbranch_scc1 L_comm
    s_lshl_b32 s6, s4, 23
    s_lshl_b32 s7, s5, 16
    s_add_u32 s6, s6, s7
    s_lshl_b32 s44, s3, 13
    s_add_u32 s6, s6, s44
    s_add_u32 s6, s6, 7340032
    s_add_u32 s40, s18, s6
    s_addc_u32 s41, s19, 0
    s_add_u32 s42, s20, s6
    s_addc_u32 s43, s21, 0
    v_lshrrev_b32 v3, 4, v2
    v_and_b32 v4, 15, v2
    v_lshlrev_b32 v5, 8, v3
    v_add_u32 v6, 0, v3
    v_xor_b32 v7, v6, v4
    v_lshl_add_u32 v8, v7, 4, v5
    v_and_b32 v6, 7, v6
    v_lshlrev_b32 v6, 1, v6
    v_xor_b32 v7, v6, v4
    v_lshl_add_u32 v12, v7, 4, v5
    v_add_u32 v6, 4, v3
    v_xor_b32 v7, v6, v4
    v_lshl_add_u32 v9, v7, 4, v5
    v_and_b32 v6, 7, v6
    v_lshlrev_b32 v6, 1, v6
    v_xor_b32 v7, v6, v4
    v_lshl_add_u32 v13, v7, 4, v5
    v_add_u32 v6, 8, v3
    v_xor_b32 v7, v6, v4
    v_lshl_add_u32 v10, v7, 4, v5
    v_and_b32 v6, 7, v6
    v_lshlrev_b32 v6, 1, v6
    v_xor_b32 v7, v6, v4
    v_lshl_add_u32 v14, v7, 4, v5
    v_add_u32 v6, 12, v3
    v_xor_b32 v7, v6, v4
    v_lshl_add_u32 v11, v7, 4, v5
    v_and_b32 v6, 7, v6
    v_lshlrev_b32 v6, 1, v6
    v_xor_b32 v7, v6, v4
    v_lshl_add_u32 v15, v7, 4, v5
    v_lshlrev_b32 v5, 8, v4
    v_add_u32 v5, s44, v5
    v_add_u32 v6, 0, v3
    v_xor_b32 v6, v6, v4
    v_lshl_add_u32 v32, v6, 4, v5
    v_add_u32 v6, 4, v3
    v_xor_b32 v6, v6, v4
    v_lshl_add_u32 v33, v6, 4, v5
    v_add_u32 v6, 8, v3
    v_xor_b32 v6, v6, v4
    v_lshl_add_u32 v34, v6, 4, v5
    v_add_u32 v6, 12, v3
    v_xor_b32 v6, v6, v4
    v_lshl_add_u32 v35, v6, 4, v5
    v_lshrrev_b32 v6, 2, v2
    v_and_b32 v7, 3, v2
    v_lshlrev_b32 v5, 8, v6
    v_lshl_add_u32 v5, v7, 3, v5
    v_add_u32 v5, s44, v5
    v_add_u32 v5, 65536, v5
    v_and_b32 v6, 7, v6
    v_xor_b32 v7, 0, v6
    v_lshl_add_u32 v36, v7, 5, v5
    v_xor_b32 v7, 1, v6
    v_lshl_add_u32 v37, v7, 5, v5
    v_xor_b32 v7, 2, v6
    v_lshl_add_u32 v38, v7, 5, v5
    v_xor_b32 v7, 3, v6
    v_lshl_add_u32 v39, v7, 5, v5
    v_xor_b32 v7, 4, v6
    v_lshl_add_u32 v40, v7, 5, v5
    v_xor_b32 v7, 5, v6
    v_lshl_add_u32 v41, v7, 5, v5
    v_xor_b32 v7, 6, v6
    v_lshl_add_u32 v42, v7, 5, v5
    v_xor_b32 v7, 7, v6
    v_lshl_add_u32 v43, v7, 5, v5
    v_and_b32 v1, 3, v2
    v_lshlrev_b32 v1, 8, v1
    v_lshl_add_u32 v1, v3, 4, v1
    v_add_u32 v1, 151552, v1
    s_and_b32 s6, s4, 7
    s_lshl_b32 s6, s6, 15
    s_lshr_b32 s7, s2, 7
    s_lshl_b32 s7, s7, 12
    s_add_u32 s6, s6, s7
    s_lshl_b32 s7, s3, 9
    s_add_u32 s6, s6, s7
    s_add_u32 s6, s6, 0
    v_and_b32 v5, 31, v2
    v_lshrrev_b32 v6, 5, v2
    v_lshlrev_b32 v6, 14, v6
    v_lshl_add_u32 v5, v5, 4, v6
    v_add_u32 v56, s6, v5
    v_add_u32 v57, 0x2000, v56
    s_barrier
    v_mov_b32 v6, 152996
L_wf1:
    ds_read_b32 v7, v6
    s_waitcnt lgkmcnt(0)
    v_readfirstlane_b32 s61, v7
    s_nop 3
    s_cmp_ge_u32 s61, 1
    s_cbranch_scc0 L_wf1
    s_add_u32 s45, s44, 0
    s_mov_b32 m0, s45
    s_nop 0
    global_load_lds_dwordx4 v8, s[40:41] offset:0 nt
    global_load_lds_dwordx4 v9, s[40:41] offset:1024 nt
    global_load_lds_dwordx4 v10, s[40:41] offset:2048 nt
    global_load_lds_dwordx4 v11, s[40:41] offset:3072 nt
    s_add_u32 s40, s40, 4096
    s_addc_u32 s41, s41, 0
    s_add_u32 s45, s44, 4096
    s_mov_b32 m0, s45
    s_nop 0
    global_load_lds_dwordx4 v8, s[40:41] offset:0 nt
    global_load_lds_dwordx4 v9, s[40:41] offset:1024 nt
    global_load_lds_dwordx4 v10, s[40:41] offset:2048 nt
    global_load_lds_dwordx4 v11, s[40:41] offset:3072 nt
    s_add_u32 s40, s40, 4096
    s_addc_u32 s41, s41, 0
    s_add_u32 s45, s44, 65536
    s_mov_b32 m0, s45
    s_nop 0
    v_mov_b32 v6, 153000
L_wf2:
    ds_read_b32 v7, v6
    s_waitcnt lgkmcnt(0)
    v_readfirstlane_b32 s61, v7
    s_nop 3
    s_cmp_ge_u32 s61, 1
    s_cbranch_scc0 L_wf2
    global_load_lds_dwordx4 v12, s[42:43] offset:0 nt
    global_load_lds_dwordx4 v13, s[42:43] offset:1024 nt
    global_load_lds_dwordx4 v14, s[42:43] offset:2048 nt
    global_load_dwordx4 v[44:47], v56, s[38:39] sc1
    global_load_dwordx4 v[48:51], v57, s[38:39] sc1
    global_load_lds_dwordx4 v15, s[42:43] offset:3072 nt
    s_add_u32 s42, s42, 4096
    s_addc_u32 s43, s43, 0
    s_add_u32 s45, s44, 69632
    s_mov_b32 m0, s45
    s_nop 0
    global_load_lds_dwordx4 v12, s[42:43] offset:0 nt
    global_load_lds_dwordx4 v13, s[42:43] offset:1024 nt
    global_load_lds_dwordx4 v14, s[42:43] offset:2048 nt
    global_load_lds_dwordx4 v15, s[42:43] offset:3072 nt
    s_add_u32 s42, s42, 4096
    s_addc_u32 s43, s43, 0
    v_mov_b32 v7, 152832
    ds_read_b64 v[58:59], v7
    s_waitcnt lgkmcnt(0)
    v_readfirstlane_b32 s50, v58
    v_readfirstlane_b32 s51, v59
    s_waitcnt vmcnt(5)
    v_xor_b32 v8, s50, v46
    v_xor_b32 v9, s51, v47
    v_or_b32 v8, v8, v9
    v_xor_b32 v9, s50, v50
    v_or_b32 v8, v8, v9
    v_xor_b32 v9, s51, v51
    v_or_b32 v8, v8, v9
    v_cmp_ne_u32 vcc, 0, v8
    s_nop 1
    s_and_b64 exec, exec, vcc
    s_cbranch_scc0 L_qok
    s_mov_b32 s60, 0
L_poll3:
    global_load_dwordx4 v[44:47], v56, s[38:39] sc1
    global_load_dwordx4 v[48:51], v57, s[38:39] sc1
    s_waitcnt vmcnt(0)
    v_xor_b32 v8, s50, v46
    v_xor_b32 v9, s51, v47
    v_or_b32 v8, v8, v9
    v_xor_b32 v9, s50, v50
    v_or_b32 v8, v8, v9
    v_xor_b32 v9, s51, v51
    v_or_b32 v8, v8, v9
    v_cmp_ne_u32 vcc, 0, v8
    s_nop 1
    s_and_b64 exec, exec, vcc
    s_cbranch_scc0 L_polld3
    s_add_u32 s60, s60, 1
    s_cmp_lt_u32 s60, 200000
    s_sleep 1
    s_cbranch_scc1 L_poll3
L_polld3:
    s_mov_b64 exec, -1
L_qok:
    s_mov_b64 exec, -1
    v_add_f32 v44, v44, v48
    v_add_f32 v45, v45, v49
    v_mov_b32 v8, v44
    s_nop 1
    v_permlane32_swap_b32 v44, v8
    s_nop 1
    v_add_f32 v44, v44, v8
    v_mov_b32 v8, v45
    s_nop 1
    v_permlane32_swap_b32 v45, v8
    s_nop 1
    v_add_f32 v45, v45, v8
    v_cvt_pk_bf16_f32 v44, v44, v45
    s_lshl_b32 s6, s3, 7
    s_add_u32 s6, s6, 151552
    v_and_b32 v6, 31, v2
    v_lshlrev_b32 v6, 2, v6
    v_add_u32 v6, s6, v6
    ds_write_b32 v6, v44
    s_waitcnt lgkmcnt(0)
    v_mov_b32 v8, 152980
    v_mov_b32 v9, 1
    s_mov_b64 exec, 1
    ds_add_u32 v8, v9
    s_mov_b64 exec, -1
    v_mov_b32 v8, 152980
L_wf4:
    ds_read_b32 v9, v8
    s_waitcnt lgkmcnt(0)
    v_readfirstlane_b32 s61, v9
    s_nop 3
    s_cmp_ge_u32 s61, 8
    s_cbranch_scc0 L_wf4
    ds_read_b128 v[16:19], v1 offset:0
    ds_read_b128 v[20:23], v1 offset:64
    ds_read_b128 v[24:27], v1 offset:128
    ds_read_b128 v[28:31], v1 offset:192
    ds_read_b128 v[96:99], v32 offset:0
    ds_read_b128 v[100:103], v33 offset:0
    ds_read_b128 v[104:107], v34 offset:0
    ds_read_b128 v[108:111], v35 offset:0
    ds_read_b128 v[112:115], v32 offset:4096
    ds_read_b128 v[116:119], v33 offset:4096
    ds_read_b128 v[120:123], v34 offset:4096
    ds_read_b128 v[124:127], v35 offset:4096
    s_mov_b32 s46, 0x3db504f3
    s_mov_b32 s47, 0x3fb8aa3b
    s_waitcnt lgkmcnt(0)
    v_mfma_f32_16x16x32_bf16 v[44:47], v[96:99], v[16:19], 0
    v_mfma_f32_16x16x32_bf16 v[44:47], v[100:103], v[20:23], v[44:47]
    v_mfma_f32_16x16x32_bf16 v[44:47], v[104:107], v[24:27], v[44:47]
    v_mfma_f32_16x16x32_bf16 v[44:47], v[108:111], v[28:31], v[44:47]
    v_mfma_f32_16x16x32_bf16 v[48:51], v[112:115], v[16:19], 0
    v_mfma_f32_16x16x32_bf16 v[48:51], v[116:119], v[20:23], v[48:51]
    v_mfma_f32_16x16x32_bf16 v[48:51], v[120:123], v[24:27], v[48:51]
    v_mfma_f32_16x16x32_bf16 v[48:51], v[124:127], v[28:31], v[48:51]
    s_nop 7
    s_nop 3
    v_cvt_pk_bf16_f32 v64, v44, v45
    v_lshlrev_b32 v44, 16, v64
    v_and_b32 v45, 0xffff0000, v64
    v_mul_f32 v44, s46, v44
    v_mul_f32 v45, s46, v45
    v_cvt_pk_bf16_f32 v64, v44, v45
    v_lshlrev_b32 v44, 16, v64
    v_and_b32 v45, 0xffff0000, v64
    v_cvt_pk_bf16_f32 v64, v46, v47
    v_lshlrev_b32 v46, 16, v64
    v_and_b32 v47, 0xffff0000, v64
    v_mul_f32 v46, s46, v46
    v_mul_f32 v47, s46, v47
    v_cvt_pk_bf16_f32 v64, v46, v47
    v_lshlrev_b32 v46, 16, v64
    v_and_b32 v47, 0xffff0000, v64
    v_cvt_pk_bf16_f32 v64, v48, v49
    v_lshlrev_b32 v48, 16, v64
    v_and_b32 v49, 0xffff0000, v64
    v_mul_f32 v48, s46, v48
    v_mul_f32 v49, s46, v49
    v_cvt_pk_bf16_f32 v64, v48, v49
    v_lshlrev_b32 v48, 16, v64
    v_and_b32 v49, 0xffff0000, v64
    v_cvt_pk_bf16_f32 v64, v50, v51
    v_lshlrev_b32 v50, 16, v64
    v_and_b32 v51, 0xffff0000, v64
    v_mul_f32 v50, s46, v50
    v_mul_f32 v51, s46, v51
    v_cvt_pk_bf16_f32 v64, v50, v51
    v_lshlrev_b32 v50, 16, v64
    v_and_b32 v51, 0xffff0000, v64
    v_max3_f32 v60, v44, v45, v46
    v_max3_f32 v60, v60, v47, v48
    v_max3_f32 v60, v60, v49, v50
    v_max_f32 v60, v60, v51
    v_mov_b32 v64, v60
    s_nop 1
    v_permlane16_swap_b32 v60, v64
    s_nop 1
    v_max_f32 v60, v60, v64
    v_mov_b32 v64, v60
    s_nop 1
    v_permlane32_swap_b32 v60, v64
    s_nop 1
    v_max_f32 v60, v60, v64
    s_lshl_b32 s45, s3, 4
    v_lshlrev_b32 v6, 2, v2
    v_add_u32 v6, s45, v6
    v_add_u32 v6, 152576, v6
    s_mov_b64 exec, 15
    ds_write_b32 v6, v60
    s_mov_b64 exec, -1
    s_waitcnt lgkmcnt(0)
    v_mov_b32 v64, 153016
    v_mov_b32 v65, 1
    s_mov_b64 exec, 1
    ds_add_u32 v64, v65
    s_mov_b64 exec, -1
    v_and_b32 v6, 3, v2
    v_lshlrev_b32 v6, 2, v6
    v_add_u32 v6, 152576, v6
    v_mov_b32 v64, 153016
L_wf5:
    ds_read_b32 v65, v64
    s_waitcnt lgkmcnt(0)
    v_readfirstlane_b32 s61, v65
    s_nop 3
    s_cmp_ge_u32 s61, 8
    s_cbranch_scc0 L_wf5
    ds_read_b32 v64, v6 offset:0
    ds_read_b32 v65, v6 offset:16
    ds_read_b32 v66, v6 offset:32
    ds_read_b32 v67, v6 offset:48
    ds_read_b32 v68, v6 offset:64
    ds_read_b32 v69, v6 offset:80
    ds_read_b32 v70, v6 offset:96
    ds_read_b32 v71, v6 offset:112
    s_waitcnt lgkmcnt(0)
    v_max3_f32 v60, v64, v65, v66
    v_max3_f32 v60, v60, v67, v68
    v_max3_f32 v60, v60, v69, v70
    v_max_f32 v60, v60, v71
    v_sub_f32 v44, v44, v60
    v_mul_f32 v44, s47, v44
    v_exp_f32 v44, v44
    v_sub_f32 v45, v45, v60
    v_mul_f32 v45, s47, v45
    v_exp_f32 v45, v45
    v_sub_f32 v46, v46, v60
    v_mul_f32 v46, s47, v46
    v_exp_f32 v46, v46
    v_sub_f32 v47, v47, v60
    v_mul_f32 v47, s47, v47
    v_exp_f32 v47, v47
    v_sub_f32 v48, v48, v60
    v_mul_f32 v48, s47, v48
    v_exp_f32 v48, v48
    v_sub_f32 v49, v49, v60
    v_mul_f32 v49, s47, v49
    v_exp_f32 v49, v49
    v_sub_f32 v50, v50, v60
    v_mul_f32 v50, s47, v50
    v_exp_f32 v50, v50
    v_sub_f32 v51, v51, v60
    v_mul_f32 v51, s47, v51
    v_exp_f32 v51, v51
    s_nop 0
    v_add_f32 v61, v44, v45
    v_add_f32 v61, v61, v46
    v_add_f32 v61, v61, v47
    v_add_f32 v61, v61, v48
    v_add_f32 v61, v61, v49
    v_add_f32 v61, v61, v50
    v_add_f32 v61, v61, v51
    v_cvt_pk_bf16_f32 v52, v44, v45
    v_cvt_pk_bf16_f32 v53, v46, v47
    v_cvt_pk_bf16_f32 v54, v48, v49
    v_cvt_pk_bf16_f32 v55, v50, v51
    v_mov_b32 v64, v61
    s_nop 1
    v_permlane16_swap_b32 v61, v64
    s_nop 1
    v_add_f32 v61, v61, v64
    v_mov_b32 v64, v61
    s_nop 1
    v_permlane32_swap_b32 v61, v64
    s_nop 1
    v_add_f32 v61, v61, v64
    v_lshlrev_b32 v5, 9, v4
    v_lshl_add_u32 v5, v3, 4, v5
    v_add_u32 v5, s44, v5
    s_lshl_b32 s45, s3, 4
    v_lshlrev_b32 v6, 2, v2
    v_add_u32 v6, s45, v6
    v_add_u32 v6, 152704, v6
    s_mov_b64 exec, 15
    ds_write_b32 v6, v61
    s_mov_b64 exec, -1
    s_waitcnt vmcnt(0)
    ds_read_b64_tr_b16 v[96:97], v36
    ds_read_b64_tr_b16 v[98:99], v36 offset:4096
    ds_read_b64_tr_b16 v[100:101], v37
    ds_read_b64_tr_b16 v[102:103], v37 offset:4096
    ds_read_b64_tr_b16 v[104:105], v38
    ds_read_b64_tr_b16 v[106:107], v38 offset:4096
    ds_read_b64_tr_b16 v[108:109], v39
    ds_read_b64_tr_b16 v[110:111], v39 offset:4096
    ds_read_b64_tr_b16 v[112:113], v40
    ds_read_b64_tr_b16 v[114:115], v40 offset:4096
    ds_read_b64_tr_b16 v[116:117], v41
    ds_read_b64_tr_b16 v[118:119], v41 offset:4096
    ds_read_b64_tr_b16 v[120:121], v42
    ds_read_b64_tr_b16 v[122:123], v42 offset:4096
    ds_read_b64_tr_b16 v[124:125], v43
    ds_read_b64_tr_b16 v[126:127], v43 offset:4096
    s_waitcnt lgkmcnt(14)
    v_mfma_f32_16x16x32_bf16 v[64:67], v[96:99], v[52:55], 0
    s_waitcnt lgkmcnt(12)
    v_mfma_f32_16x16x32_bf16 v[68:71], v[100:103], v[52:55], 0
    s_waitcnt lgkmcnt(10)
    v_mfma_f32_16x16x32_bf16 v[72:75], v[104:107], v[52:55], 0
    s_waitcnt lgkmcnt(8)
    v_mfma_f32_16x16x32_bf16 v[76:79], v[108:111], v[52:55], 0
    s_waitcnt lgkmcnt(6)
    v_mfma_f32_16x16x32_bf16 v[80:83], v[112:115], v[52:55], 0
    s_waitcnt lgkmcnt(4)
    v_mfma_f32_16x16x32_bf16 v[84:87], v[116:119], v[52:55], 0
    s_waitcnt lgkmcnt(2)
    v_mfma_f32_16x16x32_bf16 v[88:91], v[120:123], v[52:55], 0
    s_waitcnt lgkmcnt(0)
    v_mfma_f32_16x16x32_bf16 v[92:95], v[124:127], v[52:55], 0
    v_cmp_gt_u32 vcc, 4, v4
    s_nop 7
    s_and_saveexec_b64 s[48:49], vcc
    ds_write_b128 v5, v[64:67] offset:0
    ds_write_b128 v5, v[68:71] offset:64
    ds_write_b128 v5, v[72:75] offset:128
    ds_write_b128 v5, v[76:79] offset:192
    ds_write_b128 v5, v[80:83] offset:256
    ds_write_b128 v5, v[84:87] offset:320
    ds_write_b128 v5, v[88:91] offset:384
    ds_write_b128 v5, v[92:95] offset:448
    s_mov_b64 exec, s[48:49]
    s_waitcnt lgkmcnt(0)
    v_mov_b32 v8, 152984
    v_mov_b32 v9, 1
    s_mov_b64 exec, 1
    ds_add_u32 v8, v9
    s_mov_b64 exec, -1
    s_lshr_b32 s6, s3, 1
    s_and_b32 s7, s3, 1
    s_lshl_b32 s8, s6, 9
    s_lshl_b32 s9, s7, 8
    s_add_u32 s8, s8, s9
    v_and_b32 v5, 31, v2
    v_lshrrev_b32 v6, 5, v2
    v_lshlrev_b32 v6, 15, v6
    v_lshl_add_u32 v5, v5, 3, v6
    v_add_u32 v5, s8, v5
    s_lshl_b32 s9, s6, 2
    s_add_u32 s9, s9, 152704
    v_mov_b32 v6, s9
    v_readlane_b32 s11, v60, s6
    v_mov_b32 v8, 152984
L_wf6:
    ds_read_b32 v9, v8
    s_waitcnt lgkmcnt(0)
    v_readfirstlane_b32 s61, v9
    s_nop 3
    s_cmp_ge_u32 s61, 8
    s_cbranch_scc0 L_wf6
    ds_read_b64 v[96:97], v5 offset:0
    ds_read_b64 v[98:99], v5 offset:8192
    ds_read_b64 v[100:101], v5 offset:16384
    ds_read_b64 v[102:103], v5 offset:24576
    ds_read_b32 v104, v6 offset:0
    ds_read_b32 v105, v6 offset:16
    ds_read_b32 v106, v6 offset:32
    ds_read_b32 v107, v6 offset:48
    ds_read_b32 v108, v6 offset:64
    ds_read_b32 v109, v6 offset:80
    ds_read_b32 v110, v6 offset:96
    ds_read_b32 v111, v6 offset:112
    s_waitcnt lgkmcnt(0)
    v_add_f32 v8, v96, v98
    v_add_f32 v10, v100, v102
    v_add_f32 v9, v97, v99
    v_add_f32 v11, v101, v103
    v_add_f32 v8, v8, v10
    v_add_f32 v9, v9, v11
    v_add_f32 v13, v104, v105
    v_add_f32 v13, v13, v106
    v_add_f32 v13, v13, v107
    v_add_f32 v13, v13, v108
    v_add_f32 v13, v13, v109
    v_add_f32 v13, v13, v110
    v_add_f32 v13, v13, v111
    v_mov_b32 v10, v8
    s_nop 1
    v_permlane32_swap_b32 v8, v10
    s_nop 1
    v_add_f32 v8, v8, v10
    v_mov_b32 v10, v9
    s_nop 1
    v_permlane32_swap_b32 v9, v10
    s_nop 1
    v_add_f32 v9, v9, v10
    v_mov_b32 v10, s50
    v_mov_b32 v11, s51
    v_mov_b32 v12, s11
    v_mov_b32 v14, s50
    v_mov_b32 v15, s51
    s_lshl_b32 s8, s4, 2
    s_add_u32 s8, s8, s6
    s_lshl_b32 s9, s8, 14
    s_lshl_b32 s10, s5, 10
    s_add_u32 s9, s9, s10
    s_lshl_b32 s10, s7, 9
    s_add_u32 s9, s9, s10
    s_add_u32 s9, s9, 1048576
    v_and_b32 v5, 31, v2
    v_lshlrev_b32 v5, 4, v5
    v_add_u32 v5, s9, v5
    s_lshl_b32 s9, s8, 4
    s_add_u32 s9, s9, s5
    s_lshl_b32 s9, s9, 4
    s_add_u32 s9, s9, 524288
    v_mov_b32 v6, s9
    s_mov_b32 exec_lo, -1
    s_mov_b32 exec_hi, 0
    global_store_dwordx4 v5, v[8:11], s[38:39] sc1
    s_cmp_eq_u32 s7, 0
    s_cbranch_scc0 L_noml
    s_mov_b64 exec, 1
    global_store_dwordx4 v6, v[12:15], s[38:39] sc1
L_noml:
    s_mov_b64 exec, -1
    s_waitcnt lgkmcnt(0)
    v_mov_b32 v8, 153008
    v_mov_b32 v9, 1
    s_mov_b64 exec, 1
    ds_add_u32 v8, v9
    s_mov_b64 exec, -1
    s_endpgm
L_nonce:
    v_mov_b32 v3, 0
    v_mov_b32 v6, 152976
    v_mov_b32 v12, 0
    v_mov_b32 v13, 0
    v_mov_b32 v14, 0
    v_mov_b32 v15, 0
    ds_write_b128 v6, v[12:15]
    ds_write_b128 v6, v[12:15] offset:16
    ds_write_b128 v6, v[12:15] offset:32
    ds_write_b128 v6, v[12:15] offset:48
    s_and_b32 s6, s2, 31
    s_cmp_lg_u32 s6, 0
    s_cbranch_scc1 L_nl
    s_memrealtime s[6:7]
    s_waitcnt lgkmcnt(0)
    s_or_b32 s6, s6, 1
    v_mov_b32 v4, s6
    v_mov_b32 v5, s7
    v_mov_b32 v6, 0
    v_mov_b32 v7, 0
    s_mov_b64 exec, 1
    global_atomic_cmpswap_x2 v[8:9], v3, v[4:7], s[36:37] sc0 sc1
    s_mov_b64 exec, -1
    s_barrier
    s_waitcnt vmcnt(0)
    v_readfirstlane_b32 s8, v8
    v_readfirstlane_b32 s9, v9
    s_nop 3
    s_cmp_lg_u32 s8, 0
    s_cselect_b32 s6, s8, s6
    s_cselect_b32 s7, s9, s7
    v_mov_b32 v8, s6
    v_mov_b32 v9, s7
    s_branch L_npub
L_nl:
    s_mov_b32 s60, 0
    global_load_dwordx2 v[8:9], v3, s[36:37] sc1
    s_waitcnt lgkmcnt(0)
    s_barrier
L_npoll:
    s_waitcnt vmcnt(0)
    v_readfirstlane_b32 s8, v8
    s_nop 3
    s_cmp_lg_u32 s8, 0
    s_cbranch_scc1 L_npub
    s_add_u32 s60, s60, 1
    s_cmp_ge_u32 s60, 200000
    s_cbranch_scc1 L_npub
    global_load_dwordx2 v[8:9], v3, s[36:37] sc1
    s_branch L_npoll
L_npub:
    v_mov_b32 v7, 152832
    ds_write_b64 v7, v[8:9]
    s_waitcnt lgkmcnt(0)
    v_mov_b32 v10, 152996
    v_mov_b32 v11, 1
    s_mov_b64 exec, 1
    ds_add_u32 v10, v11
    s_mov_b64 exec, -1
    s_endpgm
L_comm:
    s_sub_u32 s3, s3, 8
    v_and_b32 v3, 255, v0
    v_lshlrev_b32 v4, 4, v2
    global_load_dwordx4 v[8:11], v4, s[16:17]
    global_load_dwordx4 v[12:15], v4, s[16:17] offset:1024
    s_and_b32 s6, s2, 7
    s_lshr_b32 s7, s2, 7
    s_lshl_b32 s7, s7, 1
    s_bfe_u32 s8, s2, 0x10003
    s_or_b32 s7, s7, s8
    s_and_b32 s8, s4, 7
    s_lshl_b32 s9, s7, 20
    s_lshl_b32 s10, s8, 10
    s_add_u32 s9, s9, s10
    s_lshl_b32 s10, s6, 7
    s_add_u32 s9, s9, s10
    s_add_u32 s40, s22, s9
    s_addc_u32 s41, s23, 0
    v_lshrrev_b32 v5, 3, v3
    v_and_b32 v6, 7, v3
    v_lshlrev_b32 v7, 13, v5
    v_lshl_add_u32 v7, v6, 4, v7
    global_load_dwordx4 v[32:35], v7, s[40:41] nt
    v_add_u32 v7, 0x40000, v7
    global_load_dwordx4 v[36:39], v7, s[40:41] nt
    v_add_u32 v7, 0x40000, v7
    global_load_dwordx4 v[40:43], v7, s[40:41] nt
    v_add_u32 v7, 0x40000, v7
    global_load_dwordx4 v[44:47], v7, s[40:41] nt
    s_and_b32 s11, s2, 3
    s_bfe_u32 s12, s2, 0x10002
    s_lshr_b32 s13, s2, 3
    s_cmp_ge_u32 s2, 224
    s_cbranch_scc1 L_nogu0
    s_cmp_eq_u32 s12, 0
    s_cselect_b32 s42, s28, s30
    s_cselect_b32 s43, s29, s31
    s_mul_i32 s9, s11, 458752
    s_lshl_b32 s10, s13, 7
    s_add_u32 s9, s9, s10
    s_add_u32 s42, s42, s9
    s_addc_u32 s43, s43, 0
    s_movk_i32 s9, 3584
    v_mul_lo_u32 v7, v5, s9
    v_lshl_add_u32 v7, v6, 4, v7
    global_load_dwordx4 v[48:51], v7, s[42:43] nt
    v_add_u32 v7, 114688, v7
    global_load_dwordx4 v[52:55], v7, s[42:43] nt
    v_add_u32 v7, 114688, v7
    global_load_dwordx4 v[56:59], v7, s[42:43] nt
    v_add_u32 v7, 114688, v7
    global_load_dwordx4 v[60:63], v7, s[42:43] nt
L_nogu0:
    v_and_b32 v7, 3, v2
    s_lshl_b32 s9, s2, 2
    v_add_u32 v7, s9, v7
    v_lshlrev_b32 v125, 1, v7
    global_load_ushort v124, v125, s[16:17]
    s_barrier
    s_cmp_ge_u32 s2, 224
    s_cbranch_scc1 L_w5
    s_waitcnt vmcnt(9)
    s_branch L_wd
L_w5:
    s_waitcnt vmcnt(5)
L_wd:
    v_lshlrev_b32 v16, 16, v8
    v_and_b32 v18, 0xffff0000, v8
    v_lshlrev_b32 v20, 16, v9
    v_and_b32 v22, 0xffff0000, v9
    v_lshlrev_b32 v24, 16, v10
    v_and_b32 v26, 0xffff0000, v10
    v_lshlrev_b32 v28, 16, v11
    v_and_b32 v30, 0xffff0000, v11
    v_lshlrev_b32 v17, 16, v12
    v_and_b32 v19, 0xffff0000, v12
    v_lshlrev_b32 v21, 16, v13
    v_and_b32 v23, 0xffff0000, v13
    v_lshlrev_b32 v25, 16, v14
    v_and_b32 v27, 0xffff0000, v14
    v_lshlrev_b32 v29, 16, v15
    v_and_b32 v31, 0xffff0000, v15
    v_add_f32 v96, v16, v18
    v_add_f32 v96, v96, v20
    v_add_f32 v96, v96, v22
    v_add_f32 v96, v96, v24
    v_add_f32 v96, v96, v26
    v_add_f32 v96, v96, v28
    v_add_f32 v96, v96, v30
    v_add_f32 v97, v17, v19
    v_add_f32 v97, v97, v21
    v_add_f32 v97, v97, v23
    v_add_f32 v97, v97, v25
    v_add_f32 v97, v97, v27
    v_add_f32 v97, v97, v29
    v_add_f32 v97, v97, v31
    s_nop 1
    v_add_f32_dpp v96, v96, v96 row_ror:8 row_mask:0xf bank_mask:0xf
    s_nop 1
    v_add_f32_dpp v96, v96, v96 row_ror:4 row_mask:0xf bank_mask:0xf
    s_nop 1
    v_add_f32_dpp v96, v96, v96 row_ror:2 row_mask:0xf bank_mask:0xf
    s_nop 1
    v_add_f32_dpp v96, v96, v96 row_ror:1 row_mask:0xf bank_mask:0xf
    v_mov_b32 v104, v96
    s_nop 1
    v_permlane16_swap_b32 v96, v104
    s_nop 1
    v_add_f32 v96, v96, v104
    v_mov_b32 v104, v96
    s_nop 1
    v_permlane32_swap_b32 v96, v104
    s_nop 1
    v_add_f32 v96, v96, v104
    v_mul_f32 v96, 0x3b000000, v96
    s_nop 1
    v_add_f32_dpp v97, v97, v97 row_ror:8 row_mask:0xf bank_mask:0xf
    s_nop 1
    v_add_f32_dpp v97, v97, v97 row_ror:4 row_mask:0xf bank_mask:0xf
    s_nop 1
    v_add_f32_dpp v97, v97, v97 row_ror:2 row_mask:0xf bank_mask:0xf
    s_nop 1
    v_add_f32_dpp v97, v97, v97 row_ror:1 row_mask:0xf bank_mask:0xf
    v_mov_b32 v104, v97
    s_nop 1
    v_permlane16_swap_b32 v97, v104
    s_nop 1
    v_add_f32 v97, v97, v104
    v_mov_b32 v104, v97
    s_nop 1
    v_permlane32_swap_b32 v97, v104
    s_nop 1
    v_add_f32 v97, v97, v104
    v_mul_f32 v97, 0x3b000000, v97
    v_sub_f32 v104, v16, v96
    v_mul_f32 v98, v104, v104
    v_sub_f32 v104, v18, v96
    v_fmac_f32 v98, v104, v104
    v_sub_f32 v104, v20, v96
    v_fmac_f32 v98, v104, v104
    v_sub_f32 v104, v22, v96
    v_fmac_f32 v98, v104, v104
    v_sub_f32 v104, v24, v96
    v_fmac_f32 v98, v104, v104
    v_sub_f32 v104, v26, v96
    v_fmac_f32 v98, v104, v104
    v_sub_f32 v104, v28, v96
    v_fmac_f32 v98, v104, v104
    v_sub_f32 v104, v30, v96
    v_fmac_f32 v98, v104, v104
    v_sub_f32 v104, v17, v97
    v_mul_f32 v99, v104, v104
    v_sub_f32 v104, v19, v97
    v_fmac_f32 v99, v104, v104
    v_sub_f32 v104, v21, v97
    v_fmac_f32 v99, v104, v104
    v_sub_f32 v104, v23, v97
    v_fmac_f32 v99, v104, v104
    v_sub_f32 v104, v25, v97
    v_fmac_f32 v99, v104, v104
    v_sub_f32 v104, v27, v97
    v_fmac_f32 v99, v104, v104
    v_sub_f32 v104, v29, v97
    v_fmac_f32 v99, v104, v104
    v_sub_f32 v104, v31, v97
    v_fmac_f32 v99, v104, v104
    s_nop 1
    v_add_f32_dpp v98, v98, v98 row_ror:8 row_mask:0xf bank_mask:0xf
    s_nop 1
    v_add_f32_dpp v98, v98, v98 row_ror:4 row_mask:0xf bank_mask:0xf
    s_nop 1
    v_add_f32_dpp v98, v98, v98 row_ror:2 row_mask:0xf bank_mask:0xf
    s_nop 1
    v_add_f32_dpp v98, v98, v98 row_ror:1 row_mask:0xf bank_mask:0xf
    v_mov_b32 v104, v98
    s_nop 1
    v_permlane16_swap_b32 v98, v104
    s_nop 1
    v_add_f32 v98, v98, v104
    v_mov_b32 v104, v98
    s_nop 1
    v_permlane32_swap_b32 v98, v104
    s_nop 1
    v_add_f32 v98, v98, v104
    v_mul_f32 v98, 0x3b000000, v98
    v_cvt_pk_bf16_f32 v96, v96, v96
    v_lshlrev_b32 v96, 16, v96
    v_cvt_pk_bf16_f32 v98, v98, v98
    v_lshlrev_b32 v98, 16, v98
    v_add_f32 v98, 0x3727c5ac, v98
    v_cvt_pk_bf16_f32 v98, v98, v98
    v_lshlrev_b32 v98, 16, v98
    v_sqrt_f32 v98, v98
    s_nop 0
    v_cvt_pk_bf16_f32 v98, v98, v98
    v_lshlrev_b32 v98, 16, v98
    v_rcp_f32 v100, v98
    s_nop 0
    s_nop 1
    v_add_f32_dpp v99, v99, v99 row_ror:8 row_mask:0xf bank_mask:0xf
    s_nop 1
    v_add_f32_dpp v99, v99, v99 row_ror:4 row_mask:0xf bank_mask:0xf
    s_nop 1
    v_add_f32_dpp v99, v99, v99 row_ror:2 row_mask:0xf bank_mask:0xf
    s_nop 1
    v_add_f32_dpp v99, v99, v99 row_ror:1 row_mask:0xf bank_mask:0xf
    v_mov_b32 v104, v99
    s_nop 1
    v_permlane16_swap_b32 v99, v104
    s_nop 1
    v_add_f32 v99, v99, v104
    v_mov_b32 v104, v99
    s_nop 1
    v_permlane32_swap_b32 v99, v104
    s_nop 1
    v_add_f32 v99, v99, v104
    v_mul_f32 v99, 0x3b000000, v99
    v_cvt_pk_bf16_f32 v97, v97, v97
    v_lshlrev_b32 v97, 16, v97
    v_cvt_pk_bf16_f32 v99, v99, v99
    v_lshlrev_b32 v99, 16, v99
    v_add_f32 v99, 0x3727c5ac, v99
    v_cvt_pk_bf16_f32 v99, v99, v99
    v_lshlrev_b32 v99, 16, v99
    v_sqrt_f32 v99, v99
    s_nop 0
    v_cvt_pk_bf16_f32 v99, v99, v99
    v_lshlrev_b32 v99, 16, v99
    v_rcp_f32 v101, v99
    s_nop 0
    v_sub_f32 v16, v16, v96
    v_cvt_pk_bf16_f32 v16, v16, v16
    v_lshlrev_b32 v16, 16, v16
    v_mul_f32 v104, v16, v100
    v_fma_f32 v105, -v104, v98, v16
    v_fma_f32 v16, v105, v100, v104
    v_cvt_pk_bf16_f32 v16, v16, v16
    v_lshlrev_b32 v16, 16, v16
    v_sub_f32 v18, v18, v96
    v_cvt_pk_bf16_f32 v18, v18, v18
    v_lshlrev_b32 v18, 16, v18
    v_mul_f32 v104, v18, v100
    v_fma_f32 v105, -v104, v98, v18
    v_fma_f32 v18, v105, v100, v104
    v_cvt_pk_bf16_f32 v18, v18, v18
    v_lshlrev_b32 v18, 16, v18
    v_sub_f32 v20, v20, v96
    v_cvt_pk_bf16_f32 v20, v20, v20
    v_lshlrev_b32 v20, 16, v20
    v_mul_f32 v104, v20, v100
    v_fma_f32 v105, -v104, v98, v20
    v_fma_f32 v20, v105, v100, v104
    v_cvt_pk_bf16_f32 v20, v20, v20
    v_lshlrev_b32 v20, 16, v20
    v_sub_f32 v22, v22, v96
    v_cvt_pk_bf16_f32 v22, v22, v22
    v_lshlrev_b32 v22, 16, v22
    v_mul_f32 v104, v22, v100
    v_fma_f32 v105, -v104, v98, v22
    v_fma_f32 v22, v105, v100, v104
    v_cvt_pk_bf16_f32 v22, v22, v22
    v_lshlrev_b32 v22, 16, v22
    v_sub_f32 v24, v24, v96
    v_cvt_pk_bf16_f32 v24, v24, v24
    v_lshlrev_b32 v24, 16, v24
    v_mul_f32 v104, v24, v100
    v_fma_f32 v105, -v104, v98, v24
    v_fma_f32 v24, v105, v100, v104
    v_cvt_pk_bf16_f32 v24, v24, v24
    v_lshlrev_b32 v24, 16, v24
    v_sub_f32 v26, v26, v96
    v_cvt_pk_bf16_f32 v26, v26, v26
    v_lshlrev_b32 v26, 16, v26
    v_mul_f32 v104, v26, v100
    v_fma_f32 v105, -v104, v98, v26
    v_fma_f32 v26, v105, v100, v104
    v_cvt_pk_bf16_f32 v26, v26, v26
    v_lshlrev_b32 v26, 16, v26
    v_sub_f32 v28, v28, v96
    v_cvt_pk_bf16_f32 v28, v28, v28
    v_lshlrev_b32 v28, 16, v28
    v_mul_f32 v104, v28, v100
    v_fma_f32 v105, -v104, v98, v28
    v_fma_f32 v28, v105, v100, v104
    v_cvt_pk_bf16_f32 v28, v28, v28
    v_lshlrev_b32 v28, 16, v28
    v_sub_f32 v30, v30, v96
    v_cvt_pk_bf16_f32 v30, v30, v30
    v_lshlrev_b32 v30, 16, v30
    v_mul_f32 v104, v30, v100
    v_fma_f32 v105, -v104, v98, v30
    v_fma_f32 v30, v105, v100, v104
    v_cvt_pk_bf16_f32 v30, v30, v30
    v_lshlrev_b32 v30, 16, v30
    v_sub_f32 v17, v17, v97
    v_cvt_pk_bf16_f32 v17, v17, v17
    v_lshlrev_b32 v17, 16, v17
    v_mul_f32 v104, v17, v101
    v_fma_f32 v105, -v104, v99, v17
    v_fma_f32 v17, v105, v101, v104
    v_cvt_pk_bf16_f32 v17, v17, v17
    v_lshlrev_b32 v17, 16, v17
    v_sub_f32 v19, v19, v97
    v_cvt_pk_bf16_f32 v19, v19, v19
    v_lshlrev_b32 v19, 16, v19
    v_mul_f32 v104, v19, v101
    v_fma_f32 v105, -v104, v99, v19
    v_fma_f32 v19, v105, v101, v104
    v_cvt_pk_bf16_f32 v19, v19, v19
    v_lshlrev_b32 v19, 16, v19
    v_sub_f32 v21, v21, v97
    v_cvt_pk_bf16_f32 v21, v21, v21
    v_lshlrev_b32 v21, 16, v21
    v_mul_f32 v104, v21, v101
    v_fma_f32 v105, -v104, v99, v21
    v_fma_f32 v21, v105, v101, v104
    v_cvt_pk_bf16_f32 v21, v21, v21
    v_lshlrev_b32 v21, 16, v21
    v_sub_f32 v23, v23, v97
    v_cvt_pk_bf16_f32 v23, v23, v23
    v_lshlrev_b32 v23, 16, v23
    v_mul_f32 v104, v23, v101
    v_fma_f32 v105, -v104, v99, v23
    v_fma_f32 v23, v105, v101, v104
    v_cvt_pk_bf16_f32 v23, v23, v23
    v_lshlrev_b32 v23, 16, v23
    v_sub_f32 v25, v25, v97
    v_cvt_pk_bf16_f32 v25, v25, v25
    v_lshlrev_b32 v25, 16, v25
    v_mul_f32 v104, v25, v101
    v_fma_f32 v105, -v104, v99, v25
    v_fma_f32 v25, v105, v101, v104
    v_cvt_pk_bf16_f32 v25, v25, v25
    v_lshlrev_b32 v25, 16, v25
    v_sub_f32 v27, v27, v97
    v_cvt_pk_bf16_f32 v27, v27, v27
    v_lshlrev_b32 v27, 16, v27
    v_mul_f32 v104, v27, v101
    v_fma_f32 v105, -v104, v99, v27
    v_fma_f32 v27, v105, v101, v104
    v_cvt_pk_bf16_f32 v27, v27, v27
    v_lshlrev_b32 v27, 16, v27
    v_sub_f32 v29, v29, v97
    v_cvt_pk_bf16_f32 v29, v29, v29
    v_lshlrev_b32 v29, 16, v29
    v_mul_f32 v104, v29, v101
    v_fma_f32 v105, -v104, v99, v29
    v_fma_f32 v29, v105, v101, v104
    v_cvt_pk_bf16_f32 v29, v29, v29
    v_lshlrev_b32 v29, 16, v29
    v_sub_f32 v31, v31, v97
    v_cvt_pk_bf16_f32 v31, v31, v31
    v_lshlrev_b32 v31, 16, v31
    v_mul_f32 v104, v31, v101
    v_fma_f32 v105, -v104, v99, v31
    v_fma_f32 v31, v105, v101, v104
    v_cvt_pk_bf16_f32 v31, v31, v31
    v_lshlrev_b32 v31, 16, v31
    v_lshlrev_b32 v7, 6, v2
    v_add_u32 v7, 131072, v7
    ds_write_b128 v7, v[16:19] offset:0
    ds_write_b128 v7, v[20:23] offset:16
    ds_write_b128 v7, v[24:27] offset:32
    ds_write_b128 v7, v[28:31] offset:48
    s_waitcnt lgkmcnt(0)
    s_lshl_b32 s9, s7, 10
    s_add_u32 s9, s9, 131072
    v_lshlrev_b32 v7, 3, v5
    v_add_u32 v6, s9, v7
    ds_read_b64 v[16:17], v6 offset:0
    ds_read_b64 v[18:19], v6 offset:256
    ds_read_b64 v[20:21], v6 offset:512
    ds_read_b64 v[22:23], v6 offset:768
    s_lshl_b32 s9, s11, 10
    s_add_u32 s9, s9, 131072
    v_add_u32 v6, s9, v7
    ds_read_b64 v[24:25], v6 offset:0
    ds_read_b64 v[26:27], v6 offset:256
    ds_read_b64 v[28:29], v6 offset:512
    ds_read_b64 v[30:31], v6 offset:768
    s_cmp_ge_u32 s2, 224
    s_cbranch_scc1 L_w1
    s_waitcnt vmcnt(5) lgkmcnt(0)
    s_branch L_w1d
L_w1:
    s_waitcnt vmcnt(1) lgkmcnt(0)
L_w1d:
    v_lshlrev_b32 v96, 16, v32
    v_and_b32 v97, 0xffff0000, v32
    v_mul_f32 v64, v16, v96
    v_mul_f32 v65, v16, v97
    v_mul_f32 v72, v17, v96
    v_mul_f32 v73, v17, v97
    v_lshlrev_b32 v96, 16, v33
    v_and_b32 v97, 0xffff0000, v33
    v_mul_f32 v66, v16, v96
    v_mul_f32 v67, v16, v97
    v_mul_f32 v74, v17, v96
    v_mul_f32 v75, v17, v97
    v_lshlrev_b32 v96, 16, v34
    v_and_b32 v97, 0xffff0000, v34
    v_mul_f32 v68, v16, v96
    v_mul_f32 v69, v16, v97
    v_mul_f32 v76, v17, v96
    v_mul_f32 v77, v17, v97
    v_lshlrev_b32 v96, 16, v35
    v_and_b32 v97, 0xffff0000, v35
    v_mul_f32 v70, v16, v96
    v_mul_f32 v71, v16, v97
    v_mul_f32 v78, v17, v96
    v_mul_f32 v79, v17, v97
    v_lshlrev_b32 v96, 16, v36
    v_and_b32 v97, 0xffff0000, v36
    v_fmac_f32 v64, v18, v96
    v_fmac_f32 v65, v18, v97
    v_fmac_f32 v72, v19, v96
    v_fmac_f32 v73, v19, v97
    v_lshlrev_b32 v96, 16, v37
    v_and_b32 v97, 0xffff0000, v37
    v_fmac_f32 v66, v18, v96
    v_fmac_f32 v67, v18, v97
    v_fmac_f32 v74, v19, v96
    v_fmac_f32 v75, v19, v97
    v_lshlrev_b32 v96, 16, v38
    v_and_b32 v97, 0xffff0000, v38
    v_fmac_f32 v68, v18, v96
    v_fmac_f32 v69, v18, v97
    v_fmac_f32 v76, v19, v96
    v_fmac_f32 v77, v19, v97
    v_lshlrev_b32 v96, 16, v39
    v_and_b32 v97, 0xffff0000, v39
    v_fmac_f32 v70, v18, v96
    v_fmac_f32 v71, v18, v97
    v_fmac_f32 v78, v19, v96
    v_fmac_f32 v79, v19, v97
    v_lshlrev_b32 v96, 16, v40
    v_and_b32 v97, 0xffff0000, v40
    v_fmac_f32 v64, v20, v96
    v_fmac_f32 v65, v20, v97
    v_fmac_f32 v72, v21, v96
    v_fmac_f32 v73, v21, v97
    v_lshlrev_b32 v96, 16, v41
    v_and_b32 v97, 0xffff0000, v41
    v_fmac_f32 v66, v20, v96
    v_fmac_f32 v67, v20, v97
    v_fmac_f32 v74, v21, v96
    v_fmac_f32 v75, v21, v97
    v_lshlrev_b32 v96, 16, v42
    v_and_b32 v97, 0xffff0000, v42
    v_fmac_f32 v68, v20, v96
    v_fmac_f32 v69, v20, v97
    v_fmac_f32 v76, v21, v96
    v_fmac_f32 v77, v21, v97
    v_lshlrev_b32 v96, 16, v43
    v_and_b32 v97, 0xffff0000, v43
    v_fmac_f32 v70, v20, v96
    v_fmac_f32 v71, v20, v97
    v_fmac_f32 v78, v21, v96
    v_fmac_f32 v79, v21, v97
    v_lshlrev_b32 v96, 16, v44
    v_and_b32 v97, 0xffff0000, v44
    v_fmac_f32 v64, v22, v96
    v_fmac_f32 v65, v22, v97
    v_fmac_f32 v72, v23, v96
    v_fmac_f32 v73, v23, v97
    v_lshlrev_b32 v96, 16, v45
    v_and_b32 v97, 0xffff0000, v45
    v_fmac_f32 v66, v22, v96
    v_fmac_f32 v67, v22, v97
    v_fmac_f32 v74, v23, v96
    v_fmac_f32 v75, v23, v97
    v_lshlrev_b32 v96, 16, v46
    v_and_b32 v97, 0xffff0000, v46
    v_fmac_f32 v68, v22, v96
    v_fmac_f32 v69, v22, v97
    v_fmac_f32 v76, v23, v96
    v_fmac_f32 v77, v23, v97
    v_lshlrev_b32 v96, 16, v47
    v_and_b32 v97, 0xffff0000, v47
    v_fmac_f32 v70, v22, v96
    v_fmac_f32 v71, v22, v97
    v_fmac_f32 v78, v23, v96
    v_fmac_f32 v79, v23, v97
    s_nop 1
    v_add_f32_dpp v64, v64, v64 row_shr:8 row_mask:0xf bank_mask:0xf bound_ctrl:0
    v_add_f32_dpp v65, v65, v65 row_shr:8 row_mask:0xf bank_mask:0xf bound_ctrl:0
    v_add_f32_dpp v66, v66, v66 row_shr:8 row_mask:0xf bank_mask:0xf bound_ctrl:0
    v_add_f32_dpp v67, v67, v67 row_shr:8 row_mask:0xf bank_mask:0xf bound_ctrl:0
    v_add_f32_dpp v68, v68, v68 row_shr:8 row_mask:0xf bank_mask:0xf bound_ctrl:0
    v_add_f32_dpp v69, v69, v69 row_shr:8 row_mask:0xf bank_mask:0xf bound_ctrl:0
    v_add_f32_dpp v70, v70, v70 row_shr:8 row_mask:0xf bank_mask:0xf bound_ctrl:0
    v_add_f32_dpp v71, v71, v71 row_shr:8 row_mask:0xf bank_mask:0xf bound_ctrl:0
    v_add_f32_dpp v72, v72, v72 row_shr:8 row_mask:0xf bank_mask:0xf bound_ctrl:0
    v_add_f32_dpp v73, v73, v73 row_shr:8 row_mask:0xf bank_mask:0xf bound_ctrl:0
    v_add_f32_dpp v74, v74, v74 row_shr:8 row_mask:0xf bank_mask:0xf bound_ctrl:0
    v_add_f32_dpp v75, v75, v75 row_shr:8 row_mask:0xf bank_mask:0xf bound_ctrl:0
    v_add_f32_dpp v76, v76, v76 row_shr:8 row_mask:0xf bank_mask:0xf bound_ctrl:0
    v_add_f32_dpp v77, v77, v77 row_shr:8 row_mask:0xf bank_mask:0xf bound_ctrl:0
    v_add_f32_dpp v78, v78, v78 row_shr:8 row_mask:0xf bank_mask:0xf bound_ctrl:0
    v_add_f32_dpp v79, v79, v79 row_shr:8 row_mask:0xf bank_mask:0xf bound_ctrl:0
    v_lshrrev_b32 v6, 4, v2
    s_lshl_b32 s9, s3, 2
    v_add_u32 v6, s9, v6
    v_lshlrev_b32 v6, 9, v6
    v_and_b32 v7, 7, v2
    v_lshl_add_u32 v6, v7, 5, v6
    v_add_u32 v6, 135168, v6
    v_and_b32 v7, 8, v2
    v_cmp_ne_u32 vcc, 0, v7
    s_nop 1
    s_and_saveexec_b64 s[48:49], vcc
    ds_write_b128 v6, v[64:67] offset:0
    ds_write_b128 v6, v[68:71] offset:16
    ds_write_b128 v6, v[72:75] offset:256
    ds_write_b128 v6, v[76:79] offset:272
    s_mov_b64 exec, s[48:49]
    s_waitcnt lgkmcnt(0)
    v_mov_b32 v96, 152976
    v_mov_b32 v97, 1
    s_mov_b64 exec, 1
    ds_add_u32 v96, v97
    s_mov_b64 exec, -1
    v_mov_b32 v96, 152996
L_wf7:
    ds_read_b32 v97, v96
    s_waitcnt lgkmcnt(0)
    v_readfirstlane_b32 s61, v97
    s_nop 3
    s_cmp_ge_u32 s61, 1
    s_cbranch_scc0 L_wf7
    v_mov_b32 v7, 152832
    ds_read_b64 v[4:5], v7
    s_waitcnt lgkmcnt(0)
    v_readfirstlane_b32 s50, v4
    v_readfirstlane_b32 s51, v5
    s_cmp_eq_u32 s3, 0
    s_cbranch_scc0 L_notq
    s_lshl_b32 s9, s8, 2
    s_add_u32 s9, s9, s7
    s_lshl_b32 s9, s9, 13
    s_lshl_b32 s10, s6, 9
    s_add_u32 s9, s9, s10
    s_add_u32 s9, s9, 0
    v_lshrrev_b32 v6, 5, v2
    v_and_b32 v7, 31, v2
    v_lshlrev_b32 v6, 12, v6
    v_lshl_add_u32 v6, v7, 4, v6
    v_add_u32 v4, s9, v6
    v_lshlrev_b32 v6, 3, v2
    v_add_u32 v6, 135168, v6
    v_mov_b32 v96, 152976
L_wf8:
    ds_read_b32 v97, v96
    s_waitcnt lgkmcnt(0)
    v_readfirstlane_b32 s61, v97
    s_nop 3
    s_cmp_ge_u32 s61, 4
    s_cbranch_scc0 L_wf8
    ds_read_b64 v[64:65], v6 offset:0
    ds_read_b64 v[66:67], v6 offset:512
    ds_read_b64 v[68:69], v6 offset:1024
    ds_read_b64 v[70:71], v6 offset:1536
    ds_read_b64 v[72:73], v6 offset:2048
    ds_read_b64 v[74:75], v6 offset:2560
    ds_read_b64 v[76:77], v6 offset:3072
    ds_read_b64 v[78:79], v6 offset:3584
    ds_read_b64 v[80:81], v6 offset:4096
    ds_read_b64 v[82:83], v6 offset:4608
    ds_read_b64 v[84:85], v6 offset:5120
    ds_read_b64 v[86:87], v6 offset:5632
    ds_read_b64 v[88:89], v6 offset:6144
    ds_read_b64 v[90:91], v6 offset:6656
    ds_read_b64 v[92:93], v6 offset:7168
    ds_read_b64 v[94:95], v6 offset:7680
    s_waitcnt lgkmcnt(0)
    v_add_f32 v108, v64, v66
    v_add_f32 v109, v65, v67
    v_add_f32 v108, v108, v68
    v_add_f32 v109, v109, v69
    v_add_f32 v108, v108, v70
    v_add_f32 v109, v109, v71
    v_add_f32 v108, v108, v72
    v_add_f32 v109, v109, v73
    v_add_f32 v108, v108, v74
    v_add_f32 v109, v109, v75
    v_add_f32 v108, v108, v76
    v_add_f32 v109, v109, v77
    v_add_f32 v108, v108, v78
    v_add_f32 v109, v109, v79
    v_add_f32 v108, v108, v80
    v_add_f32 v109, v109, v81
    v_add_f32 v108, v108, v82
    v_add_f32 v109, v109, v83
    v_add_f32 v108, v108, v84
    v_add_f32 v109, v109, v85
    v_add_f32 v108, v108, v86
    v_add_f32 v109, v109, v87
    v_add_f32 v108, v108, v88
    v_add_f32 v109, v109, v89
    v_add_f32 v108, v108, v90
    v_add_f32 v109, v109, v91
    v_add_f32 v108, v108, v92
    v_add_f32 v109, v109, v93
    v_add_f32 v108, v108, v94
    v_add_f32 v109, v109, v95
    v_mov_b32 v110, s50
    v_mov_b32 v111, s51
    global_store_dwordx4 v4, v[108:111], s[38:39] sc1
    s_waitcnt lgkmcnt(0)
    v_mov_b32 v96, 153000
    v_mov_b32 v97, 1
    s_mov_b64 exec, 1
    ds_add_u32 v96, v97
    s_mov_b64 exec, -1
L_notq:
    s_cmp_ge_u32 s2, 224
    s_cbranch_scc1 L_pubdone
    s_waitcnt vmcnt(1)
    v_lshlrev_b32 v96, 16, v48
    v_and_b32 v97, 0xffff0000, v48
    v_mul_f32 v80, v24, v96
    v_mul_f32 v81, v24, v97
    v_mul_f32 v88, v25, v96
    v_mul_f32 v89, v25, v97
    v_lshlrev_b32 v96, 16, v49
    v_and_b32 v97, 0xffff0000, v49
    v_mul_f32 v82, v24, v96
    v_mul_f32 v83, v24, v97
    v_mul_f32 v90, v25, v96
    v_mul_f32 v91, v25, v97
    v_lshlrev_b32 v96, 16, v50
    v_and_b32 v97, 0xffff0000, v50
    v_mul_f32 v84, v24, v96
    v_mul_f32 v85, v24, v97
    v_mul_f32 v92, v25, v96
    v_mul_f32 v93, v25, v97
    v_lshlrev_b32 v96, 16, v51
    v_and_b32 v97, 0xffff0000, v51
    v_mul_f32 v86, v24, v96
    v_mul_f32 v87, v24, v97
    v_mul_f32 v94, v25, v96
    v_mul_f32 v95, v25, v97
    v_lshlrev_b32 v96, 16, v52
    v_and_b32 v97, 0xffff0000, v52
    v_fmac_f32 v80, v26, v96
    v_fmac_f32 v81, v26, v97
    v_fmac_f32 v88, v27, v96
    v_fmac_f32 v89, v27, v97
    v_lshlrev_b32 v96, 16, v53
    v_and_b32 v97, 0xffff0000, v53
    v_fmac_f32 v82, v26, v96
    v_fmac_f32 v83, v26, v97
    v_fmac_f32 v90, v27, v96
    v_fmac_f32 v91, v27, v97
    v_lshlrev_b32 v96, 16, v54
    v_and_b32 v97, 0xffff0000, v54
    v_fmac_f32 v84, v26, v96
    v_fmac_f32 v85, v26, v97
    v_fmac_f32 v92, v27, v96
    v_fmac_f32 v93, v27, v97
    v_lshlrev_b32 v96, 16, v55
    v_and_b32 v97, 0xffff0000, v55
    v_fmac_f32 v86, v26, v96
    v_fmac_f32 v87, v26, v97
    v_fmac_f32 v94, v27, v96
    v_fmac_f32 v95, v27, v97
    v_lshlrev_b32 v96, 16, v56
    v_and_b32 v97, 0xffff0000, v56
    v_fmac_f32 v80, v28, v96
    v_fmac_f32 v81, v28, v97
    v_fmac_f32 v88, v29, v96
    v_fmac_f32 v89, v29, v97
    v_lshlrev_b32 v96, 16, v57
    v_and_b32 v97, 0xffff0000, v57
    v_fmac_f32 v82, v28, v96
    v_fmac_f32 v83, v28, v97
    v_fmac_f32 v90, v29, v96
    v_fmac_f32 v91, v29, v97
    v_lshlrev_b32 v96, 16, v58
    v_and_b32 v97, 0xffff0000, v58
    v_fmac_f32 v84, v28, v96
    v_fmac_f32 v85, v28, v97
    v_fmac_f32 v92, v29, v96
    v_fmac_f32 v93, v29, v97
    v_lshlrev_b32 v96, 16, v59
    v_and_b32 v97, 0xffff0000, v59
    v_fmac_f32 v86, v28, v96
    v_fmac_f32 v87, v28, v97
    v_fmac_f32 v94, v29, v96
    v_fmac_f32 v95, v29, v97
    v_lshlrev_b32 v96, 16, v60
    v_and_b32 v97, 0xffff0000, v60
    v_fmac_f32 v80, v30, v96
    v_fmac_f32 v81, v30, v97
    v_fmac_f32 v88, v31, v96
    v_fmac_f32 v89, v31, v97
    v_lshlrev_b32 v96, 16, v61
    v_and_b32 v97, 0xffff0000, v61
    v_fmac_f32 v82, v30, v96
    v_fmac_f32 v83, v30, v97
    v_fmac_f32 v90, v31, v96
    v_fmac_f32 v91, v31, v97
    v_lshlrev_b32 v96, 16, v62
    v_and_b32 v97, 0xffff0000, v62
    v_fmac_f32 v84, v30, v96
    v_fmac_f32 v85, v30, v97
    v_fmac_f32 v92, v31, v96
    v_fmac_f32 v93, v31, v97
    v_lshlrev_b32 v96, 16, v63
    v_and_b32 v97, 0xffff0000, v63
    v_fmac_f32 v86, v30, v96
    v_fmac_f32 v87, v30, v97
    v_fmac_f32 v94, v31, v96
    v_fmac_f32 v95, v31, v97
    s_nop 1
    v_add_f32_dpp v80, v80, v80 row_shr:8 row_mask:0xf bank_mask:0xf bound_ctrl:0
    v_add_f32_dpp v81, v81, v81 row_shr:8 row_mask:0xf bank_mask:0xf bound_ctrl:0
    v_add_f32_dpp v82, v82, v82 row_shr:8 row_mask:0xf bank_mask:0xf bound_ctrl:0
    v_add_f32_dpp v83, v83, v83 row_shr:8 row_mask:0xf bank_mask:0xf bound_ctrl:0
    v_add_f32_dpp v84, v84, v84 row_shr:8 row_mask:0xf bank_mask:0xf bound_ctrl:0
    v_add_f32_dpp v85, v85, v85 row_shr:8 row_mask:0xf bank_mask:0xf bound_ctrl:0
    v_add_f32_dpp v86, v86, v86 row_shr:8 row_mask:0xf bank_mask:0xf bound_ctrl:0
    v_add_f32_dpp v87, v87, v87 row_shr:8 row_mask:0xf bank_mask:0xf bound_ctrl:0
    v_add_f32_dpp v88, v88, v88 row_shr:8 row_mask:0xf bank_mask:0xf bound_ctrl:0
    v_add_f32_dpp v89, v89, v89 row_shr:8 row_mask:0xf bank_mask:0xf bound_ctrl:0
    v_add_f32_dpp v90, v90, v90 row_shr:8 row_mask:0xf bank_mask:0xf bound_ctrl:0
    v_add_f32_dpp v91, v91, v91 row_shr:8 row_mask:0xf bank_mask:0xf bound_ctrl:0
    v_add_f32_dpp v92, v92, v92 row_shr:8 row_mask:0xf bank_mask:0xf bound_ctrl:0
    v_add_f32_dpp v93, v93, v93 row_shr:8 row_mask:0xf bank_mask:0xf bound_ctrl:0
    v_add_f32_dpp v94, v94, v94 row_shr:8 row_mask:0xf bank_mask:0xf bound_ctrl:0
    v_add_f32_dpp v95, v95, v95 row_shr:8 row_mask:0xf bank_mask:0xf bound_ctrl:0
    v_lshrrev_b32 v6, 4, v2
    s_lshl_b32 s9, s3, 2
    v_add_u32 v6, s9, v6
    v_lshlrev_b32 v6, 9, v6
    v_and_b32 v7, 7, v2
    v_lshl_add_u32 v6, v7, 5, v6
    v_add_u32 v6, 135168, v6
    v_and_b32 v7, 8, v2
    v_cmp_ne_u32 vcc, 0, v7
    s_nop 1
    s_and_saveexec_b64 s[48:49], vcc
    ds_write_b128 v6, v[80:83] offset:8192
    ds_write_b128 v6, v[84:87] offset:8208
    ds_write_b128 v6, v[88:91] offset:8448
    ds_write_b128 v6, v[92:95] offset:8464
    s_mov_b64 exec, s[48:49]
    s_waitcnt lgkmcnt(0)
    v_mov_b32 v96, 153012
    v_mov_b32 v97, 1
    s_mov_b64 exec, 1
    ds_add_u32 v96, v97
    s_mov_b64 exec, -1
    s_cmp_eq_u32 s3, 1
    s_cbranch_scc0 L_pubdone
    s_lshl_b32 s9, s12, 2
    s_add_u32 s9, s9, s11
    s_mul_i32 s9, s9, 1792
    s_lshl_b32 s10, s13, 6
    s_add_u32 s9, s9, s10
    s_lshl_b32 s9, s9, 4
    s_add_u32 s9, s9, 262144
    v_lshlrev_b32 v4, 4, v2
    v_add_u32 v4, s9, v4
    v_lshlrev_b32 v6, 2, v2
    v_add_u32 v6, 143360, v6
    v_mov_b32 v96, 153012
L_wf9:
    ds_read_b32 v97, v96
    s_waitcnt lgkmcnt(0)
    v_readfirstlane_b32 s61, v97
    s_nop 3
    s_cmp_ge_u32 s61, 4
    s_cbranch_scc0 L_wf9
    ds_read_b32 v64, v6 offset:0
    ds_read_b32 v65, v6 offset:256
    ds_read_b32 v66, v6 offset:512
    ds_read_b32 v67, v6 offset:768
    ds_read_b32 v68, v6 offset:1024
    ds_read_b32 v69, v6 offset:1280
    ds_read_b32 v70, v6 offset:1536
    ds_read_b32 v71, v6 offset:1792
    ds_read_b32 v72, v6 offset:2048
    ds_read_b32 v73, v6 offset:2304
    ds_read_b32 v74, v6 offset:2560
    ds_read_b32 v75, v6 offset:2816
    ds_read_b32 v76, v6 offset:3072
    ds_read_b32 v77, v6 offset:3328
    ds_read_b32 v78, v6 offset:3584
    ds_read_b32 v79, v6 offset:3840
    ds_read_b32 v80, v6 offset:4096
    ds_read_b32 v81, v6 offset:4352
    ds_read_b32 v82, v6 offset:4608
    ds_read_b32 v83, v6 offset:4864
    ds_read_b32 v84, v6 offset:5120
    ds_read_b32 v85, v6 offset:5376
    ds_read_b32 v86, v6 offset:5632
    ds_read_b32 v87, v6 offset:5888
    ds_read_b32 v88, v6 offset:6144
    ds_read_b32 v89, v6 offset:6400
    ds_read_b32 v90, v6 offset:6656
    ds_read_b32 v91, v6 offset:6912
    ds_read_b32 v92, v6 offset:7168
    ds_read_b32 v93, v6 offset:7424
    ds_read_b32 v94, v6 offset:7680
    ds_read_b32 v95, v6 offset:7936
    s_waitcnt lgkmcnt(0)
    v_add_f32 v108, v64, v66
    v_add_f32 v109, v65, v67
    v_add_f32 v108, v108, v68
    v_add_f32 v109, v109, v69
    v_add_f32 v108, v108, v70
    v_add_f32 v109, v109, v71
    v_add_f32 v108, v108, v72
    v_add_f32 v109, v109, v73
    v_add_f32 v108, v108, v74
    v_add_f32 v109, v109, v75
    v_add_f32 v108, v108, v76
    v_add_f32 v109, v109, v77
    v_add_f32 v108, v108, v78
    v_add_f32 v109, v109, v79
    v_add_f32 v108, v108, v80
    v_add_f32 v109, v109, v81
    v_add_f32 v108, v108, v82
    v_add_f32 v109, v109, v83
    v_add_f32 v108, v108, v84
    v_add_f32 v109, v109, v85
    v_add_f32 v108, v108, v86
    v_add_f32 v109, v109, v87
    v_add_f32 v108, v108, v88
    v_add_f32 v109, v109, v89
    v_add_f32 v108, v108, v90
    v_add_f32 v109, v109, v91
    v_add_f32 v108, v108, v92
    v_add_f32 v109, v109, v93
    v_add_f32 v108, v108, v94
    v_add_f32 v109, v109, v95
    v_mov_b32 v110, s50
    v_mov_b32 v111, s51
    global_store_dwordx4 v4, v[108:111], s[38:39] sc1
L_pubdone:
    s_lshr_b32 s14, s2, 3
    s_and_b32 s15, s2, 7
    v_lshrrev_b32 v5, 3, v3
    v_and_b32 v6, 7, v3
    v_lshlrev_b32 v4, 10, v5
    v_lshl_add_u32 v4, v6, 4, v4
    s_lshl_b32 s9, s14, 17
    s_lshl_b32 s10, s15, 7
    s_add_u32 s9, s9, s10
    s_add_u32 s64, s24, s9
    s_addc_u32 s65, s25, 0
    v_lshrrev_b32 v6, 2, v3
    v_min_u32 v6, 55, v6
    v_and_b32 v7, 3, v3
    s_movk_i32 s9, 1792
    v_mul_lo_u32 v7, v7, s9
    v_add_u32 v7, v7, v6
    s_mul_i32 s9, s14, 56
    v_add_u32 v7, s9, v7
    v_lshlrev_b32 v7, 4, v7
    v_add_u32 v8, 262144, v7
    v_add_u32 v9, 376832, v7
    s_mov_b32 s60, 0
L_poll10:
    global_load_dwordx4 v[108:111], v8, s[38:39] sc1
    global_load_dwordx4 v[112:115], v9, s[38:39] sc1
    s_waitcnt vmcnt(0)
    v_xor_b32 v96, s50, v110
    v_xor_b32 v97, s51, v111
    v_or_b32 v96, v96, v97
    v_xor_b32 v97, s50, v114
    v_or_b32 v96, v96, v97
    v_xor_b32 v97, s51, v115
    v_or_b32 v96, v96, v97
    v_cmp_ne_u32 vcc, 0, v96
    s_nop 1
    s_and_b64 exec, exec, vcc
    s_cbranch_scc0 L_polld10
    s_add_u32 s60, s60, 1
    s_cmp_lt_u32 s60, 200000
    s_sleep 1
    s_cbranch_scc1 L_poll10
L_polld10:
    s_mov_b64 exec, -1
    s_nop 1
    v_add_f32_dpp v108, v108, v108 quad_perm:[1,0,3,2] row_mask:0xf bank_mask:0xf
    v_add_f32_dpp v109, v109, v109 quad_perm:[1,0,3,2] row_mask:0xf bank_mask:0xf
    v_add_f32_dpp v112, v112, v112 quad_perm:[1,0,3,2] row_mask:0xf bank_mask:0xf
    v_add_f32_dpp v113, v113, v113 quad_perm:[1,0,3,2] row_mask:0xf bank_mask:0xf
    s_nop 1
    v_add_f32_dpp v108, v108, v108 quad_perm:[2,3,0,1] row_mask:0xf bank_mask:0xf
    v_add_f32_dpp v109, v109, v109 quad_perm:[2,3,0,1] row_mask:0xf bank_mask:0xf
    v_add_f32_dpp v112, v112, v112 quad_perm:[2,3,0,1] row_mask:0xf bank_mask:0xf
    v_add_f32_dpp v113, v113, v113 quad_perm:[2,3,0,1] row_mask:0xf bank_mask:0xf
    v_cvt_pk_bf16_f32 v108, v108, v108
    v_lshlrev_b32 v108, 16, v108
    v_cvt_pk_bf16_f32 v109, v109, v109
    v_lshlrev_b32 v109, 16, v109
    v_cvt_pk_bf16_f32 v112, v112, v112
    v_lshlrev_b32 v112, 16, v112
    v_cvt_pk_bf16_f32 v113, v113, v113
    v_lshlrev_b32 v113, 16, v113
    s_mov_b32 s47, 0x3fb8aa3b
    v_mul_f32 v96, -v108, s47
    v_exp_f32 v96, v96
    s_nop 0
    v_add_f32 v96, 1.0, v96
    v_rcp_f32 v96, v96
    s_nop 0
    v_mul_f32 v96, v96, v108
    v_cvt_pk_bf16_f32 v96, v96, v96
    v_lshlrev_b32 v96, 16, v96
    v_mul_f32 v96, v96, v112
    v_cvt_pk_bf16_f32 v116, v96, v96
    v_lshlrev_b32 v116, 16, v116
    v_mul_f32 v96, -v109, s47
    v_exp_f32 v96, v96
    s_nop 0
    v_add_f32 v96, 1.0, v96
    v_rcp_f32 v96, v96
    s_nop 0
    v_mul_f32 v96, v96, v109
    v_cvt_pk_bf16_f32 v96, v96, v96
    v_lshlrev_b32 v96, 16, v96
    v_mul_f32 v96, v96, v113
    v_cvt_pk_bf16_f32 v117, v96, v96
    v_lshlrev_b32 v117, 16, v117
    v_lshlrev_b32 v6, 3, v6
    v_add_u32 v6, 153040, v6
    ds_write_b64 v6, v[116:117]
    s_waitcnt lgkmcnt(0)
    v_mov_b32 v96, 152992
    v_mov_b32 v97, 1
    s_mov_b64 exec, 1
    ds_add_u32 v96, v97
    s_mov_b64 exec, -1
    v_bfe_u32 v6, v2, 4, 1
    v_and_b32 v7, 15, v2
    v_lshlrev_b32 v6, 13, v6
    v_lshl_add_u32 v6, v7, 4, v6
    s_lshl_b32 s9, s14, 8
    s_add_u32 s9, s9, 524288
    v_add_u32 v10, s9, v6
    s_lshl_b32 s9, s14, 14
    s_lshl_b32 s10, s3, 12
    s_add_u32 s9, s9, s10
    s_add_u32 s9, s9, 1048576
    v_lshlrev_b32 v6, 4, v2
    v_add_u32 v8, s9, v6
    v_add_u32 v9, 0x80000, v8
    v_mov_b32 v96, 152992
L_wf11:
    ds_read_b32 v97, v96
    s_waitcnt lgkmcnt(0)
    v_readfirstlane_b32 s61, v97
    s_nop 3
    s_cmp_ge_u32 s61, 4
    s_cbranch_scc0 L_wf11
    v_mov_b32 v96, 153016
L_wf12:
    ds_read_b32 v97, v96
    s_waitcnt lgkmcnt(0)
    v_readfirstlane_b32 s61, v97
    s_nop 3
    s_cmp_ge_u32 s61, 8
    s_cbranch_scc0 L_wf12
    s_lshl_b32 s10, s15, 7
    v_mov_b32 v7, v4
    global_load_dwordx4 v[32:35], v7, s[64:65] nt
    v_add_u32 v7, 0x8000, v7
    global_load_dwordx4 v[36:39], v7, s[64:65] nt
    v_add_u32 v7, 0x8000, v7
    global_load_dwordx4 v[40:43], v7, s[64:65] nt
    v_add_u32 v7, 0x8000, v7
    global_load_dwordx4 v[44:47], v7, s[64:65] nt
    s_mul_i32 s9, s14, 57344
    s_add_u32 s9, s9, s10
    s_add_u32 s44, s32, s9
    s_addc_u32 s45, s33, 0
    global_load_dwordx4 v[48:51], v4, s[44:45] nt
    v_add_u32 v7, 0x8000, v4
    v_cmp_gt_u32 vcc, 24, v5
    s_nop 1
    v_cndmask_b32 v7, v4, v7, vcc
    global_load_dwordx4 v[52:55], v7, s[44:45] nt
    v_lshlrev_b32 v6, 3, v5
    v_add_u32 v6, 153040, v6
    ds_read_b64 v[100:101], v6
    ds_read_b64 v[102:103], v6 offset:256
    s_waitcnt lgkmcnt(0)
    v_cmp_gt_u32 vcc, 24, v5
    s_nop 1
    v_cndmask_b32 v102, 0, v102, vcc
    v_cndmask_b32 v103, 0, v103, vcc
    s_waitcnt vmcnt(0)
    v_lshlrev_b32 v96, 16, v48
    v_and_b32 v97, 0xffff0000, v48
    v_mul_f32 v80, v100, v96
    v_mul_f32 v81, v100, v97
    v_mul_f32 v88, v101, v96
    v_mul_f32 v89, v101, v97
    v_lshlrev_b32 v96, 16, v49
    v_and_b32 v97, 0xffff0000, v49
    v_mul_f32 v82, v100, v96
    v_mul_f32 v83, v100, v97
    v_mul_f32 v90, v101, v96
    v_mul_f32 v91, v101, v97
    v_lshlrev_b32 v96, 16, v50
    v_and_b32 v97, 0xffff0000, v50
    v_mul_f32 v84, v100, v96
    v_mul_f32 v85, v100, v97
    v_mul_f32 v92, v101, v96
    v_mul_f32 v93, v101, v97
    v_lshlrev_b32 v96, 16, v51
    v_and_b32 v97, 0xffff0000, v51
    v_mul_f32 v86, v100, v96
    v_mul_f32 v87, v100, v97
    v_mul_f32 v94, v101, v96
    v_mul_f32 v95, v101, v97
    v_lshlrev_b32 v96, 16, v52
    v_and_b32 v97, 0xffff0000, v52
    v_fmac_f32 v80, v102, v96
    v_fmac_f32 v81, v102, v97
    v_fmac_f32 v88, v103, v96
    v_fmac_f32 v89, v103, v97
    v_lshlrev_b32 v96, 16, v53
    v_and_b32 v97, 0xffff0000, v53
    v_fmac_f32 v82, v102, v96
    v_fmac_f32 v83, v102, v97
    v_fmac_f32 v90, v103, v96
    v_fmac_f32 v91, v103, v97
    v_lshlrev_b32 v96, 16, v54
    v_and_b32 v97, 0xffff0000, v54
    v_fmac_f32 v84, v102, v96
    v_fmac_f32 v85, v102, v97
    v_fmac_f32 v92, v103, v96
    v_fmac_f32 v93, v103, v97
    v_lshlrev_b32 v96, 16, v55
    v_and_b32 v97, 0xffff0000, v55
    v_fmac_f32 v86, v102, v96
    v_fmac_f32 v87, v102, v97
    v_fmac_f32 v94, v103, v96
    v_fmac_f32 v95, v103, v97
    s_nop 1
    v_add_f32_dpp v80, v80, v80 row_shr:8 row_mask:0xf bank_mask:0xf bound_ctrl:0
    v_add_f32_dpp v81, v81, v81 row_shr:8 row_mask:0xf bank_mask:0xf bound_ctrl:0
    v_add_f32_dpp v82, v82, v82 row_shr:8 row_mask:0xf bank_mask:0xf bound_ctrl:0
    v_add_f32_dpp v83, v83, v83 row_shr:8 row_mask:0xf bank_mask:0xf bound_ctrl:0
    v_add_f32_dpp v84, v84, v84 row_shr:8 row_mask:0xf bank_mask:0xf bound_ctrl:0
    v_add_f32_dpp v85, v85, v85 row_shr:8 row_mask:0xf bank_mask:0xf bound_ctrl:0
    v_add_f32_dpp v86, v86, v86 row_shr:8 row_mask:0xf bank_mask:0xf bound_ctrl:0
    v_add_f32_dpp v87, v87, v87 row_shr:8 row_mask:0xf bank_mask:0xf bound_ctrl:0
    v_add_f32_dpp v88, v88, v88 row_shr:8 row_mask:0xf bank_mask:0xf bound_ctrl:0
    v_add_f32_dpp v89, v89, v89 row_shr:8 row_mask:0xf bank_mask:0xf bound_ctrl:0
    v_add_f32_dpp v90, v90, v90 row_shr:8 row_mask:0xf bank_mask:0xf bound_ctrl:0
    v_add_f32_dpp v91, v91, v91 row_shr:8 row_mask:0xf bank_mask:0xf bound_ctrl:0
    v_add_f32_dpp v92, v92, v92 row_shr:8 row_mask:0xf bank_mask:0xf bound_ctrl:0
    v_add_f32_dpp v93, v93, v93 row_shr:8 row_mask:0xf bank_mask:0xf bound_ctrl:0
    v_add_f32_dpp v94, v94, v94 row_shr:8 row_mask:0xf bank_mask:0xf bound_ctrl:0
    v_add_f32_dpp v95, v95, v95 row_shr:8 row_mask:0xf bank_mask:0xf bound_ctrl:0
    v_lshrrev_b32 v6, 4, v2
    s_lshl_b32 s9, s3, 2
    v_add_u32 v6, s9, v6
    v_lshlrev_b32 v6, 9, v6
    v_and_b32 v7, 7, v2
    v_lshl_add_u32 v6, v7, 5, v6
    v_add_u32 v6, 135168, v6
    v_and_b32 v7, 8, v2
    v_cmp_ne_u32 vcc, 0, v7
    s_nop 1
    s_and_saveexec_b64 s[48:49], vcc
    ds_write_b128 v6, v[80:83] offset:8192
    ds_write_b128 v6, v[84:87] offset:8208
    ds_write_b128 v6, v[88:91] offset:8448
    ds_write_b128 v6, v[92:95] offset:8464
    s_mov_b64 exec, s[48:49]
    s_waitcnt lgkmcnt(0)
    v_mov_b32 v96, 153020
    v_mov_b32 v97, 1
    s_mov_b64 exec, 1
    ds_add_u32 v96, v97
    s_mov_b64 exec, -1
    s_cmp_ge_u32 s3, 2
    s_cbranch_scc1 L_nobs
    v_lshlrev_b32 v6, 2, v3
    v_add_u32 v6, 143360, v6
    v_mov_b32 v96, 153020
L_wf13:
    ds_read_b32 v97, v96
    s_waitcnt lgkmcnt(0)
    v_readfirstlane_b32 s61, v97
    s_nop 3
    s_cmp_ge_u32 s61, 4
    s_cbranch_scc0 L_wf13
    ds_read_b32 v80, v6 offset:0
    ds_read_b32 v81, v6 offset:512
    ds_read_b32 v82, v6 offset:1024
    ds_read_b32 v83, v6 offset:1536
    ds_read_b32 v84, v6 offset:2048
    ds_read_b32 v85, v6 offset:2560
    ds_read_b32 v86, v6 offset:3072
    ds_read_b32 v87, v6 offset:3584
    ds_read_b32 v88, v6 offset:4096
    ds_read_b32 v89, v6 offset:4608
    ds_read_b32 v90, v6 offset:5120
    ds_read_b32 v91, v6 offset:5632
    ds_read_b32 v92, v6 offset:6144
    ds_read_b32 v93, v6 offset:6656
    ds_read_b32 v94, v6 offset:7168
    ds_read_b32 v95, v6 offset:7680
    s_waitcnt lgkmcnt(0)
    v_add_f32 v126, v80, v81
    v_add_f32 v126, v126, v82
    v_add_f32 v126, v126, v83
    v_add_f32 v126, v126, v84
    v_add_f32 v126, v126, v85
    v_add_f32 v126, v126, v86
    v_add_f32 v126, v126, v87
    v_add_f32 v126, v126, v88
    v_add_f32 v126, v126, v89
    v_add_f32 v126, v126, v90
    v_add_f32 v126, v126, v91
    v_add_f32 v126, v126, v92
    v_add_f32 v126, v126, v93
    v_add_f32 v126, v126, v94
    v_add_f32 v126, v126, v95
L_nobs:
    v_lshlrev_b32 v80, 16, v32
    v_and_b32 v81, 0xffff0000, v32
    v_lshlrev_b32 v82, 16, v33
    v_and_b32 v83, 0xffff0000, v33
    v_lshlrev_b32 v84, 16, v34
    v_and_b32 v85, 0xffff0000, v34
    v_lshlrev_b32 v86, 16, v35
    v_and_b32 v87, 0xffff0000, v35
    v_lshlrev_b32 v88, 16, v36
    v_and_b32 v89, 0xffff0000, v36
    v_lshlrev_b32 v90, 16, v37
    v_and_b32 v91, 0xffff0000, v37
    v_lshlrev_b32 v92, 16, v38
    v_and_b32 v93, 0xffff0000, v38
    v_lshlrev_b32 v94, 16, v39
    v_and_b32 v95, 0xffff0000, v39
    v_mov_b32 v96, v40
    v_mov_b32 v97, v41
    v_mov_b32 v98, v42
    v_mov_b32 v99, v43
    v_mov_b32 v100, v44
    v_mov_b32 v101, v45
    v_mov_b32 v102, v46
    v_mov_b32 v103, v47
    v_lshlrev_b32 v32, 16, v96
    v_and_b32 v33, 0xffff0000, v96
    v_lshlrev_b32 v34, 16, v97
    v_and_b32 v35, 0xffff0000, v97
    v_lshlrev_b32 v36, 16, v98
    v_and_b32 v37, 0xffff0000, v98
    v_lshlrev_b32 v38, 16, v99
    v_and_b32 v39, 0xffff0000, v99
    v_lshlrev_b32 v40, 16, v100
    v_and_b32 v41, 0xffff0000, v100
    v_lshlrev_b32 v42, 16, v101
    v_and_b32 v43, 0xffff0000, v101
    v_lshlrev_b32 v44, 16, v102
    v_and_b32 v45, 0xffff0000, v102
    v_lshlrev_b32 v46, 16, v103
    v_and_b32 v47, 0xffff0000, v103
    v_mov_b32 v96, 153008
L_wf14:
    ds_read_b32 v97, v96
    s_waitcnt lgkmcnt(0)
    v_readfirstlane_b32 s61, v97
    s_nop 3
    s_cmp_ge_u32 s61, 8
    s_cbranch_scc0 L_wf14
    s_mov_b32 s60, 0
L_poll15:
    global_load_dwordx4 v[56:59], v10, s[38:39] sc1
    global_load_dwordx4 v[16:19], v8, s[38:39] offset:0 sc1
    global_load_dwordx4 v[20:23], v8, s[38:39] offset:1024 sc1
    global_load_dwordx4 v[24:27], v8, s[38:39] offset:2048 sc1
    global_load_dwordx4 v[28:31], v8, s[38:39] offset:3072 sc1
    global_load_dwordx4 v[108:111], v9, s[38:39] offset:0 sc1
    global_load_dwordx4 v[112:115], v9, s[38:39] offset:1024 sc1
    global_load_dwordx4 v[116:119], v9, s[38:39] offset:2048 sc1
    global_load_dwordx4 v[120:123], v9, s[38:39] offset:3072 sc1
    s_waitcnt vmcnt(0)
    v_xor_b32 v96, s50, v58
    v_xor_b32 v97, s51, v59
    v_or_b32 v96, v96, v97
    v_xor_b32 v97, s50, v18
    v_or_b32 v96, v96, v97
    v_xor_b32 v97, s51, v19
    v_or_b32 v96, v96, v97
    v_xor_b32 v97, s50, v22
    v_or_b32 v96, v96, v97
    v_xor_b32 v97, s51, v23
    v_or_b32 v96, v96, v97
    v_xor_b32 v97, s50, v26
    v_or_b32 v96, v96, v97
    v_xor_b32 v97, s51, v27
    v_or_b32 v96, v96, v97
    v_xor_b32 v97, s50, v30
    v_or_b32 v96, v96, v97
    v_xor_b32 v97, s51, v31
    v_or_b32 v96, v96, v97
    v_xor_b32 v97, s50, v110
    v_or_b32 v96, v96, v97
    v_xor_b32 v97, s51, v111
    v_or_b32 v96, v96, v97
    v_xor_b32 v97, s50, v114
    v_or_b32 v96, v96, v97
    v_xor_b32 v97, s51, v115
    v_or_b32 v96, v96, v97
    v_xor_b32 v97, s50, v118
    v_or_b32 v96, v96, v97
    v_xor_b32 v97, s51, v119
    v_or_b32 v96, v96, v97
    v_xor_b32 v97, s50, v122
    v_or_b32 v96, v96, v97
    v_xor_b32 v97, s51, v123
    v_or_b32 v96, v96, v97
    v_cmp_ne_u32 vcc, 0, v96
    s_nop 1
    s_and_b64 exec, exec, vcc
    s_cbranch_scc0 L_polld15
    s_add_u32 s60, s60, 1
    s_cmp_lt_u32 s60, 200000
    s_sleep 1
    s_cbranch_scc1 L_poll15
L_polld15:
    s_mov_b64 exec, -1
    v_mov_b32 v98, v56
    s_nop 1
    v_max_f32_dpp v98, v98, v98 row_ror:8 row_mask:0xf bank_mask:0xf
    s_nop 1
    v_max_f32_dpp v98, v98, v98 row_ror:4 row_mask:0xf bank_mask:0xf
    s_nop 1
    v_max_f32_dpp v98, v98, v98 row_ror:2 row_mask:0xf bank_mask:0xf
    s_nop 1
    v_max_f32_dpp v98, v98, v98 row_ror:1 row_mask:0xf bank_mask:0xf
    v_sub_f32 v99, v56, v98
    v_mul_f32 v99, s47, v99
    v_exp_f32 v99, v99
    s_lshl_b32 s9, s3, 2
    v_mul_f32 v100, v57, v99
    s_nop 1
    v_add_f32_dpp v100, v100, v100 row_ror:8 row_mask:0xf bank_mask:0xf
    s_nop 1
    v_add_f32_dpp v100, v100, v100 row_ror:4 row_mask:0xf bank_mask:0xf
    s_nop 1
    v_add_f32_dpp v100, v100, v100 row_ror:2 row_mask:0xf bank_mask:0xf
    s_nop 1
    v_add_f32_dpp v100, v100, v100 row_ror:1 row_mask:0xf bank_mask:0xf
    v_rcp_f32 v100, v100
    s_add_u32 s10, s9, 0
    s_nop 0
    v_readlane_b32 s52, v99, s10
    s_add_u32 s10, s9, 1
    s_nop 0
    v_readlane_b32 s53, v99, s10
    s_add_u32 s10, s9, 2
    s_nop 0
    v_readlane_b32 s54, v99, s10
    s_add_u32 s10, s9, 3
    s_nop 0
    v_readlane_b32 s55, v99, s10
    s_add_u32 s10, s9, 16
    s_nop 0
    v_readlane_b32 s56, v99, s10
    s_add_u32 s10, s9, 17
    s_nop 0
    v_readlane_b32 s57, v99, s10
    s_add_u32 s10, s9, 18
    s_nop 0
    v_readlane_b32 s58, v99, s10
    s_add_u32 s10, s9, 19
    s_nop 0
    v_readlane_b32 s59, v99, s10
    v_readlane_b32 s62, v100, 0
    v_readlane_b32 s63, v100, 16
    s_nop 1
    v_mul_f32 v100, s52, v16
    v_fmac_f32 v100, s53, v20
    v_fmac_f32 v100, s54, v24
    v_fmac_f32 v100, s55, v28
    v_mul_f32 v102, s52, v17
    v_fmac_f32 v102, s53, v21
    v_fmac_f32 v102, s54, v25
    v_fmac_f32 v102, s55, v29
    v_mul_f32 v101, s56, v108
    v_fmac_f32 v101, s57, v112
    v_fmac_f32 v101, s58, v116
    v_fmac_f32 v101, s59, v120
    v_mul_f32 v103, s56, v109
    v_fmac_f32 v103, s57, v113
    v_fmac_f32 v103, s58, v117
    v_fmac_f32 v103, s59, v121
    s_lshl_b32 s9, s3, 10
    s_add_u32 s9, s9, 131072
    v_lshlrev_b32 v6, 4, v2
    v_add_u32 v6, s9, v6
    ds_write_b128 v6, v[100:103]
    s_waitcnt lgkmcnt(0)
    v_mov_b32 v96, 153004
    v_mov_b32 v97, 1
    s_mov_b64 exec, 1
    ds_add_u32 v96, v97
    s_mov_b64 exec, -1
    v_lshlrev_b32 v6, 3, v5
    v_add_u32 v6, 131072, v6
    v_mov_b32 v96, 153004
L_wf16:
    ds_read_b32 v97, v96
    s_waitcnt lgkmcnt(0)
    v_readfirstlane_b32 s61, v97
    s_nop 3
    s_cmp_ge_u32 s61, 4
    s_cbranch_scc0 L_wf16
    ds_read_b64 v[16:17], v6 offset:0
    ds_read_b64 v[18:19], v6 offset:1024
    ds_read_b64 v[20:21], v6 offset:2048
    ds_read_b64 v[22:23], v6 offset:3072
    ds_read_b64 v[24:25], v6 offset:256
    ds_read_b64 v[26:27], v6 offset:1280
    ds_read_b64 v[28:29], v6 offset:2304
    ds_read_b64 v[30:31], v6 offset:3328
    ds_read_b64 v[108:109], v6 offset:512
    ds_read_b64 v[110:111], v6 offset:1536
    ds_read_b64 v[112:113], v6 offset:2560
    ds_read_b64 v[114:115], v6 offset:3584
    ds_read_b64 v[116:117], v6 offset:768
    ds_read_b64 v[118:119], v6 offset:1792
    ds_read_b64 v[120:121], v6 offset:2816
    ds_read_b64 v[122:123], v6 offset:3840
    s_waitcnt lgkmcnt(0)
    v_add_f32 v56, v16, v18
    v_add_f32 v96, v20, v22
    v_add_f32 v56, v56, v96
    v_mul_f32 v56, s62, v56
    v_cvt_pk_bf16_f32 v56, v56, v56
    v_lshlrev_b32 v56, 16, v56
    v_add_f32 v57, v17, v19
    v_add_f32 v96, v21, v23
    v_add_f32 v57, v57, v96
    v_mul_f32 v57, s63, v57
    v_cvt_pk_bf16_f32 v57, v57, v57
    v_lshlrev_b32 v57, 16, v57
    v_add_f32 v58, v24, v26
    v_add_f32 v96, v28, v30
    v_add_f32 v58, v58, v96
    v_mul_f32 v58, s62, v58
    v_cvt_pk_bf16_f32 v58, v58, v58
    v_lshlrev_b32 v58, 16, v58
    v_add_f32 v59, v25, v27
    v_add_f32 v96, v29, v31
    v_add_f32 v59, v59, v96
    v_mul_f32 v59, s63, v59
    v_cvt_pk_bf16_f32 v59, v59, v59
    v_lshlrev_b32 v59, 16, v59
    v_add_f32 v60, v108, v110
    v_add_f32 v96, v112, v114
    v_add_f32 v60, v60, v96
    v_mul_f32 v60, s62, v60
    v_cvt_pk_bf16_f32 v60, v60, v60
    v_lshlrev_b32 v60, 16, v60
    v_add_f32 v61, v109, v111
    v_add_f32 v96, v113, v115
    v_add_f32 v61, v61, v96
    v_mul_f32 v61, s63, v61
    v_cvt_pk_bf16_f32 v61, v61, v61
    v_lshlrev_b32 v61, 16, v61
    v_add_f32 v62, v116, v118
    v_add_f32 v96, v120, v122
    v_add_f32 v62, v62, v96
    v_mul_f32 v62, s62, v62
    v_cvt_pk_bf16_f32 v62, v62, v62
    v_lshlrev_b32 v62, 16, v62
    v_add_f32 v63, v117, v119
    v_add_f32 v96, v121, v123
    v_add_f32 v63, v63, v96
    v_mul_f32 v63, s63, v63
    v_cvt_pk_bf16_f32 v63, v63, v63
    v_lshlrev_b32 v63, 16, v63
    v_pk_mul_f32 v[64:65], v[80:81], v[56:57] op_sel:[0,0] op_sel_hi:[1,0]
    v_pk_mul_f32 v[66:67], v[82:83], v[56:57] op_sel:[0,0] op_sel_hi:[1,0]
    v_pk_mul_f32 v[68:69], v[84:85], v[56:57] op_sel:[0,0] op_sel_hi:[1,0]
    v_pk_mul_f32 v[70:71], v[86:87], v[56:57] op_sel:[0,0] op_sel_hi:[1,0]
    v_pk_mul_f32 v[72:73], v[80:81], v[56:57] op_sel:[0,1] op_sel_hi:[1,1]
    v_pk_mul_f32 v[74:75], v[82:83], v[56:57] op_sel:[0,1] op_sel_hi:[1,1]
    v_pk_mul_f32 v[76:77], v[84:85], v[56:57] op_sel:[0,1] op_sel_hi:[1,1]
    v_pk_mul_f32 v[78:79], v[86:87], v[56:57] op_sel:[0,1] op_sel_hi:[1,1]
    v_pk_fma_f32 v[64:65], v[88:89], v[58:59], v[64:65] op_sel:[0,0,0] op_sel_hi:[1,0,1]
    v_pk_fma_f32 v[66:67], v[90:91], v[58:59], v[66:67] op_sel:[0,0,0] op_sel_hi:[1,0,1]
    v_pk_fma_f32 v[68:69], v[92:93], v[58:59], v[68:69] op_sel:[0,0,0] op_sel_hi:[1,0,1]
    v_pk_fma_f32 v[70:71], v[94:95], v[58:59], v[70:71] op_sel:[0,0,0] op_sel_hi:[1,0,1]
    v_pk_fma_f32 v[72:73], v[88:89], v[58:59], v[72:73] op_sel:[0,1,0] op_sel_hi:[1,1,1]
    v_pk_fma_f32 v[74:75], v[90:91], v[58:59], v[74:75] op_sel:[0,1,0] op_sel_hi:[1,1,1]
    v_pk_fma_f32 v[76:77], v[92:93], v[58:59], v[76:77] op_sel:[0,1,0] op_sel_hi:[1,1,1]
    v_pk_fma_f32 v[78:79], v[94:95], v[58:59], v[78:79] op_sel:[0,1,0] op_sel_hi:[1,1,1]
    v_pk_fma_f32 v[64:65], v[32:33], v[60:61], v[64:65] op_sel:[0,0,0] op_sel_hi:[1,0,1]
    v_pk_fma_f32 v[66:67], v[34:35], v[60:61], v[66:67] op_sel:[0,0,0] op_sel_hi:[1,0,1]
    v_pk_fma_f32 v[68:69], v[36:37], v[60:61], v[68:69] op_sel:[0,0,0] op_sel_hi:[1,0,1]
    v_pk_fma_f32 v[70:71], v[38:39], v[60:61], v[70:71] op_sel:[0,0,0] op_sel_hi:[1,0,1]
    v_pk_fma_f32 v[72:73], v[32:33], v[60:61], v[72:73] op_sel:[0,1,0] op_sel_hi:[1,1,1]
    v_pk_fma_f32 v[74:75], v[34:35], v[60:61], v[74:75] op_sel:[0,1,0] op_sel_hi:[1,1,1]
    v_pk_fma_f32 v[76:77], v[36:37], v[60:61], v[76:77] op_sel:[0,1,0] op_sel_hi:[1,1,1]
    v_pk_fma_f32 v[78:79], v[38:39], v[60:61], v[78:79] op_sel:[0,1,0] op_sel_hi:[1,1,1]
    v_pk_fma_f32 v[64:65], v[40:41], v[62:63], v[64:65] op_sel:[0,0,0] op_sel_hi:[1,0,1]
    v_pk_fma_f32 v[66:67], v[42:43], v[62:63], v[66:67] op_sel:[0,0,0] op_sel_hi:[1,0,1]
    v_pk_fma_f32 v[68:69], v[44:45], v[62:63], v[68:69] op_sel:[0,0,0] op_sel_hi:[1,0,1]
    v_pk_fma_f32 v[70:71], v[46:47], v[62:63], v[70:71] op_sel:[0,0,0] op_sel_hi:[1,0,1]
    v_pk_fma_f32 v[72:73], v[40:41], v[62:63], v[72:73] op_sel:[0,1,0] op_sel_hi:[1,1,1]
    v_pk_fma_f32 v[74:75], v[42:43], v[62:63], v[74:75] op_sel:[0,1,0] op_sel_hi:[1,1,1]
    v_pk_fma_f32 v[76:77], v[44:45], v[62:63], v[76:77] op_sel:[0,1,0] op_sel_hi:[1,1,1]
    v_pk_fma_f32 v[78:79], v[46:47], v[62:63], v[78:79] op_sel:[0,1,0] op_sel_hi:[1,1,1]
    s_nop 1
    v_add_f32_dpp v64, v64, v64 row_shr:8 row_mask:0xf bank_mask:0xf bound_ctrl:0
    v_add_f32_dpp v65, v65, v65 row_shr:8 row_mask:0xf bank_mask:0xf bound_ctrl:0
    v_add_f32_dpp v66, v66, v66 row_shr:8 row_mask:0xf bank_mask:0xf bound_ctrl:0
    v_add_f32_dpp v67, v67, v67 row_shr:8 row_mask:0xf bank_mask:0xf bound_ctrl:0
    v_add_f32_dpp v68, v68, v68 row_shr:8 row_mask:0xf bank_mask:0xf bound_ctrl:0
    v_add_f32_dpp v69, v69, v69 row_shr:8 row_mask:0xf bank_mask:0xf bound_ctrl:0
    v_add_f32_dpp v70, v70, v70 row_shr:8 row_mask:0xf bank_mask:0xf bound_ctrl:0
    v_add_f32_dpp v71, v71, v71 row_shr:8 row_mask:0xf bank_mask:0xf bound_ctrl:0
    v_add_f32_dpp v72, v72, v72 row_shr:8 row_mask:0xf bank_mask:0xf bound_ctrl:0
    v_add_f32_dpp v73, v73, v73 row_shr:8 row_mask:0xf bank_mask:0xf bound_ctrl:0
    v_add_f32_dpp v74, v74, v74 row_shr:8 row_mask:0xf bank_mask:0xf bound_ctrl:0
    v_add_f32_dpp v75, v75, v75 row_shr:8 row_mask:0xf bank_mask:0xf bound_ctrl:0
    v_add_f32_dpp v76, v76, v76 row_shr:8 row_mask:0xf bank_mask:0xf bound_ctrl:0
    v_add_f32_dpp v77, v77, v77 row_shr:8 row_mask:0xf bank_mask:0xf bound_ctrl:0
    v_add_f32_dpp v78, v78, v78 row_shr:8 row_mask:0xf bank_mask:0xf bound_ctrl:0
    v_add_f32_dpp v79, v79, v79 row_shr:8 row_mask:0xf bank_mask:0xf bound_ctrl:0
    v_lshrrev_b32 v6, 4, v2
    s_lshl_b32 s9, s3, 2
    v_add_u32 v6, s9, v6
    v_lshlrev_b32 v6, 9, v6
    v_and_b32 v7, 7, v2
    v_lshl_add_u32 v6, v7, 5, v6
    v_add_u32 v6, 135168, v6
    v_and_b32 v7, 8, v2
    v_cmp_ne_u32 vcc, 0, v7
    s_nop 1
    s_and_saveexec_b64 s[48:49], vcc
    ds_write_b128 v6, v[64:67] offset:0
    ds_write_b128 v6, v[68:71] offset:16
    ds_write_b128 v6, v[72:75] offset:256
    ds_write_b128 v6, v[76:79] offset:272
    s_mov_b64 exec, s[48:49]
    s_waitcnt lgkmcnt(0)
    v_mov_b32 v96, 152988
    v_mov_b32 v97, 1
    s_mov_b64 exec, 1
    ds_add_u32 v96, v97
    s_mov_b64 exec, -1
    s_cmp_ge_u32 s3, 2
    s_cbranch_scc1 L_cend
    v_lshlrev_b32 v6, 2, v3
    v_add_u32 v6, 135168, v6
    s_mul_i32 s9, s2, 2112
    s_add_u32 s9, s9, 2097152
    v_lshlrev_b32 v4, 4, v3
    v_add_u32 v4, s9, v4
    v_mov_b32 v96, 152988
L_wf17:
    ds_read_b32 v97, v96
    s_waitcnt lgkmcnt(0)
    v_readfirstlane_b32 s61, v97
    s_nop 3
    s_cmp_ge_u32 s61, 4
    s_cbranch_scc0 L_wf17
    ds_read_b32 v16, v6 offset:0
    ds_read_b32 v17, v6 offset:512
    ds_read_b32 v18, v6 offset:1024
    ds_read_b32 v19, v6 offset:1536
    ds_read_b32 v20, v6 offset:2048
    ds_read_b32 v21, v6 offset:2560
    ds_read_b32 v22, v6 offset:3072
    ds_read_b32 v23, v6 offset:3584
    ds_read_b32 v24, v6 offset:4096
    ds_read_b32 v25, v6 offset:4608
    ds_read_b32 v26, v6 offset:5120
    ds_read_b32 v27, v6 offset:5632
    ds_read_b32 v28, v6 offset:6144
    ds_read_b32 v29, v6 offset:6656
    ds_read_b32 v30, v6 offset:7168
    ds_read_b32 v31, v6 offset:7680
    v_mov_b32 v109, v126
    s_waitcnt lgkmcnt(0)
    v_add_f32 v16, v16, v24
    v_add_f32 v17, v17, v25
    v_add_f32 v18, v18, v26
    v_add_f32 v19, v19, v27
    v_add_f32 v20, v20, v28
    v_add_f32 v21, v21, v29
    v_add_f32 v22, v22, v30
    v_add_f32 v23, v23, v31
    v_add_f32 v16, v16, v20
    v_add_f32 v17, v17, v21
    v_add_f32 v18, v18, v22
    v_add_f32 v19, v19, v23
    v_add_f32 v16, v16, v18
    v_add_f32 v17, v17, v19
    v_add_f32 v16, v16, v17
    v_mov_b32 v108, v16
    v_mov_b32 v110, s50
    v_mov_b32 v111, s51
    global_store_dwordx4 v4, v[108:111], s[38:39] sc1
    s_cmp_eq_u32 s3, 0
    s_cbranch_scc0 L_cend
    s_lshl_b32 s9, s2, 2
    s_and_b32 s9, s9, 511
    s_lshr_b32 s10, s9, 6
    s_and_b32 s9, s9, 63
    s_lshr_b32 s11, s2, 7
    s_lshl_b32 s11, s11, 6
    s_add_u32 s9, s9, s11
    s_lshl_b32 s9, s9, 4
    s_mul_i32 s10, s10, 2112
    s_add_u32 s9, s9, s10
    s_add_u32 s9, s9, 2097152
    v_lshrrev_b32 v5, 2, v2
    v_and_b32 v7, 3, v2
    s_movk_i32 s10, 16896
    v_mul_lo_u32 v5, v5, s10
    v_lshl_add_u32 v5, v7, 4, v5
    v_add_u32 v8, s9, v5
    v_add_u32 v9, 270336, v8
    s_mov_b32 s60, 0
L_poll18:
    global_load_dwordx4 v[16:19], v8, s[38:39] sc1
    global_load_dwordx4 v[20:23], v9, s[38:39] sc1
    s_waitcnt vmcnt(0)
    v_xor_b32 v96, s50, v18
    v_xor_b32 v97, s51, v19
    v_or_b32 v96, v96, v97
    v_xor_b32 v97, s50, v22
    v_or_b32 v96, v96, v97
    v_xor_b32 v97, s51, v23
    v_or_b32 v96, v96, v97
    v_cmp_ne_u32 vcc, 0, v96
    s_nop 1
    s_and_b64 exec, exec, vcc
    s_cbranch_scc0 L_polld18
    s_add_u32 s60, s60, 1
    s_cmp_lt_u32 s60, 200000
    s_sleep 1
    s_cbranch_scc1 L_poll18
L_polld18:
    s_mov_b64 exec, -1
    v_add_f32 v108, v16, v20
    v_add_f32 v109, v17, v21
    s_nop 1
    v_add_f32_dpp v108, v108, v108 row_ror:8 row_mask:0xf bank_mask:0xf
    v_add_f32_dpp v109, v109, v109 row_ror:8 row_mask:0xf bank_mask:0xf
    s_nop 1
    v_add_f32_dpp v108, v108, v108 row_ror:4 row_mask:0xf bank_mask:0xf
    v_add_f32_dpp v109, v109, v109 row_ror:4 row_mask:0xf bank_mask:0xf
    v_mov_b32 v96, v108
    s_nop 1
    v_permlane16_swap_b32 v108, v96
    s_nop 1
    v_add_f32 v108, v108, v96
    v_mov_b32 v96, v108
    s_nop 1
    v_permlane32_swap_b32 v108, v96
    s_nop 1
    v_add_f32 v108, v108, v96
    v_mov_b32 v96, v109
    s_nop 1
    v_permlane16_swap_b32 v109, v96
    s_nop 1
    v_add_f32 v109, v109, v96
    v_mov_b32 v96, v109
    s_nop 1
    v_permlane32_swap_b32 v109, v96
    s_nop 1
    v_add_f32 v109, v109, v96
    v_cvt_pk_bf16_f32 v108, v108, v108
    v_lshlrev_b32 v108, 16, v108
    v_cvt_pk_bf16_f32 v109, v109, v109
    v_lshlrev_b32 v109, 16, v109
    v_lshlrev_b32 v124, 16, v124
    v_add_f32 v108, v124, v108
    v_cvt_pk_bf16_f32 v108, v108, v108
    v_lshlrev_b32 v108, 16, v108
    v_add_f32 v108, v108, v109
    v_cvt_pk_bf16_f32 v108, v108, v108
    s_mov_b64 exec, 15
    global_store_short v125, v108, s[34:35]
    s_mov_b64 exec, -1
L_cend:
L_end:
    s_endpgm
.section .rodata,"a"
.p2align 6
.amdhsa_kernel parallel_sum__sliding_block_cached__swiglu_ffn__decode_kernel
  .amdhsa_next_free_vgpr 128
  .amdhsa_next_free_sgpr 96
  .amdhsa_accum_offset 128
  .amdhsa_group_segment_fixed_size 0
  .amdhsa_kernarg_size 96
  .amdhsa_user_sgpr_count 2
  .amdhsa_user_sgpr_kernarg_segment_ptr 1
  .amdhsa_system_sgpr_workgroup_id_x 1
.end_amdhsa_kernel
```
